```python
import torch

def _softmax(x, axis=-1):
    return torch.softmax(x, dim=axis)

def _gelu(x):
    return torch.nn.functional.gelu(x, approximate='tanh')

def _silu(x):
    return torch.nn.functional.silu(x)

def _sigmoid(x):
    return torch.sigmoid(x)

def _layernorm(x, axis=-1, eps=1e-05):
    m = x.mean(dim=axis, keepdim=True)
    v = x.var(dim=axis, keepdim=True, unbiased=False)
    return (x - m) / torch.sqrt(v + eps)

def _scatter_add(tgt, idx, src, axis=0):
    return tgt.clone().index_add_(axis, idx, src)

def _segment_sum(src, seg, n):
    out = torch.zeros((n,) + src.shape[1:], dtype=src.dtype)
    return out.index_add_(0, seg, src)

def _pad(x, pw):
    flat = tuple((v for pair in reversed(pw) for v in pair))
    return torch.nn.functional.pad(x, flat)
kernel_name = 'adaLN_cond__ssm_conv_h3__dense_activation_relu__prompt'

def setup_inputs():

    _w = lambda a: (lambda t: t.to(torch.bfloat16) if t.is_floating_point() else t)(torch.as_tensor(a))

    def _A_setup():
        B, S, D = (1, 2048, 512)
        ks = 4
        return {'q': _w((lambda *s: torch.randn(*s, dtype=torch.bfloat16) * 0.05)(B, S, D)), 'k': _w((lambda *s: torch.randn(*s, dtype=torch.bfloat16) * 0.8)(B, S, D)), 'v': _w((lambda *s: torch.randn(*s, dtype=torch.bfloat16) * 0.8)(B, S, D)), 'shift_k': _w((lambda *s: torch.randn(*s, dtype=torch.bfloat16) * 0.8)(D, ks) * 0.5), 'ssm_k': _w((lambda *s: torch.randn(*s, dtype=torch.bfloat16) * 0.8)(D, S) * (1.0 / S ** 0.5)), 'ssm_D': _w((lambda *s: torch.randn(*s, dtype=torch.bfloat16) * 0.8)(D))}
    _A_in = _A_setup()

    def _B_setup():
        B, S, D, Dff = (1, 2048, 512, 1792)
        return {'x': _w((lambda *s: torch.randn(*s, dtype=torch.bfloat16) * 0.05)(B, S, D)), 'w1': _w((lambda *s: torch.randn(*s, dtype=torch.bfloat16) * 0.05)(D, Dff)), 'w2': _w((lambda *s: torch.randn(*s, dtype=torch.bfloat16) * 0.05)(Dff, D))}
    _B_in = _B_setup()
    return {'A_q': _A_in['q'], 'A_k': _A_in['k'], 'A_v': _A_in['v'], 'A_shift_k': _A_in['shift_k'], 'A_ssm_k': _A_in['ssm_k'], 'A_ssm_D': _A_in['ssm_D'], 'B_x': _B_in['x'], 'B_w1': _B_in['w1'], 'B_w2': _B_in['w2'], 'c': _w((lambda *s: torch.randn(*s, dtype=torch.bfloat16) * 0.2)(1, 512) * 8.0), 'w_mod': _w((lambda *s: torch.randn(*s, dtype=torch.bfloat16) * 0.2)(512, 6 * 512) * 512 ** (-0.5) * 8.0)}

def reference(A_q, A_k, A_v, A_shift_k, A_ssm_k, A_ssm_D, B_x, B_w1, B_w2, c, w_mod):

    def _A_ref(q, k, v, shift_k, ssm_k, ssm_D):
        B, S, D = q.shape
        ks = shift_k.shape[-1]
        k_pad = _pad(k, ((0, 0), (ks - 1, 0), (0, 0)))
        k_shift = torch.zeros_like(k)
        for t in range(ks):
            k_shift = k_shift + k_pad[:, t:t + S, :] * shift_k[:, ks - 1 - t][None, None, :]
        kv = k_shift * v
        L = 2 * S
        kv_pad = _pad(kv, ((0, 0), (0, S), (0, 0)))
        kf_pad = _pad(ssm_k, ((0, 0), (0, S)))
        kv_f = (lambda x, axes=(-2, -1): torch.fft.rfft2(x.float(), dim=axes))(kv_pad[:, None, :, :], axes=(1, 2))
        kf_f = (lambda x, axes=(-2, -1): torch.fft.rfft2(x.float(), dim=axes))(kf_pad[:, None, :], axes=(1, 2))
        kf_f = (lambda x, *d: x.permute(*d))(kf_f, 1, 2, 0)
        y_f = kv_f * kf_f[None, :, :, :]
        y = (lambda x, s, axes=(-2, -1): torch.fft.irfft2(x, s=s, dim=axes).to(torch.bfloat16))(y_f, (1, L), axes=(1, 2))[:, 0, :S, :]
        y = y + kv * ssm_D[None, None, :]
        return q * y

    def _B_ref(x, w1, w2):
        h = torch.einsum('bsd,df->bsf', x, w1)
        zero = torch.zeros_like(h)
        h = torch.maximum(h, zero)
        return torch.einsum('bsf,fd->bsd', h, w2)
    x = A_q
    mod = (_silu(c) @ w_mod).reshape(c.shape[0], 6, 1, -1)
    sa, ca, ga, sb, cb, gb = (mod[:, 0].clone(), mod[:, 1].clone(), mod[:, 2].clone(), mod[:, 3].clone(), mod[:, 4].clone(), mod[:, 5].clone())
    h = _layernorm(x, axis=-1) * (1 + ca) + sa
    x = x + ga * _A_ref(h, A_k, A_v, A_shift_k, A_ssm_k, A_ssm_D)
    h = _layernorm(x, axis=-1) * (1 + cb) + sb
    x = x + gb * _B_ref(h, B_w1, B_w2)
    return x
```

```asm
; @launch kernel=k1_prep_kernel grid=(256,1,1) block=(256,1,1) lds=20480
; @launch kernel=k2_conv_kernel grid=(480,1,1) block=(256,1,1) lds=58880
; @launch kernel=k34_ffn_kernel grid=(256,1,1) block=(256,1,1) lds=136192
.amdgcn_target "amdgcn-amd-amdhsa--gfx950"
.text
.globl k1_prep_kernel
.p2align 8
.type k1_prep_kernel,@function
k1_prep_kernel:
    s_load_dwordx8 s[4:11], s[0:1], 0
    s_load_dwordx2 s[12:13], s[0:1], 32
    s_load_dwordx4 s[16:19], s[0:1], 72
    s_load_dwordx2 s[20:21], s[0:1], 104
    s_load_dwordx2 s[22:23], s[0:1], 64
    s_getpc_b64 s[28:29]
cp_1:
    s_add_u32 s28, s28, k1_top_end-cp_1
    s_addc_u32 s29, s29, 0
    s_mov_b32 s30, k1_done-k1_top_end
    s_mov_b32 s31, 0x20000
    v_mbcnt_lo_u32_b32 v202, -1, 0
    v_mbcnt_hi_u32_b32 v202, -1, v202
    v_lshlrev_b32 v202, 7, v202
    buffer_load_dword v203, v202, s[28:31], 0 offen
k1_top_end:
    s_cmp_ge_u32 s2, 256
    s_cbranch_scc1 k1_done
    s_cmp_ge_u32 s2, 8
    s_cbranch_scc1 k1_nopf
    s_getpc_b64 s[24:25]
cp_2:
    s_add_u32 s24, s24, k2_conv_kernel-cp_2
    s_addc_u32 s25, s25, 0
    s_mov_b32 s26, k34_done-k2_conv_kernel
    s_mov_b32 s27, 0x20000
    v_mbcnt_lo_u32_b32 v200, -1, 0
    v_mbcnt_hi_u32_b32 v200, -1, v200
    v_lshlrev_b32 v200, 7, v200
    buffer_load_dword v201, v200, s[24:27], 0 offen
    v_add_u32 v200, 0x2000, v200
    buffer_load_dword v201, v200, s[24:27], 0 offen
    v_add_u32 v200, 0x2000, v200
    buffer_load_dword v201, v200, s[24:27], 0 offen
    v_add_u32 v200, 0x2000, v200
    buffer_load_dword v201, v200, s[24:27], 0 offen
    v_add_u32 v200, 0x2000, v200
    buffer_load_dword v201, v200, s[24:27], 0 offen
    v_add_u32 v200, 0x2000, v200
    buffer_load_dword v201, v200, s[24:27], 0 offen
k1_nopf:
k1_pf_start:
    s_and_b32 s56, s2, 7
    s_lshr_b32 s57, s2, 3
    s_lshr_b32 s58, s57, 3
    s_lshl_b32 s59, s56, 2
    s_add_u32 s58, s58, s59
    s_and_b32 s59, s57, 7
    s_lshl_b32 s60, s58, 6
    s_lshl_b32 s61, s59, 7
    v_and_b32 v1, 31, v0
    v_lshrrev_b32 v2, 5, v0
    v_lshlrev_b32 v3, 3, v2
    v_add_u32 v3, s60, v3
    v_lshlrev_b32 v4, 10, v3
    v_lshl_add_u32 v4, v1, 2, v4
    v_add_u32 v4, s61, v4
    v_subrev_u32 v5, 3072, v4
    s_lshl_b32 s62, s59, 9
    v_lshlrev_b32 v6, 4, v1
    v_add_u32 v6, s62, v6
    v_lshrrev_b32 v7, 6, v0
    v_and_b32 v35, 63, v0
    s_lshl_b32 s63, s56, 8
    s_lshl_b32 s64, s57, 3
    s_add_u32 s63, s63, s64
    v_lshl_add_u32 v120, v7, 1, s63
    v_lshlrev_b32 v118, 2, v120
    v_lshlrev_b32 v120, 10, v120
    v_lshl_add_u32 v120, v35, 4, v120
    s_lshl_b32 s65, s2, 13
    v_lshlrev_b32 v119, 4, v0
    v_add_u32 v119, s65, v119
    s_and_b32 s71, s2, 3
    s_lshr_b32 s72, s2, 2
    s_lshl_b32 s73, s71, 7
    v_lshlrev_b32 v121, 4, v2
    v_add_u32 v121, s73, v121
    s_movk_i32 s74, 6144
    v_mul_lo_u32 v121, v121, s74
    s_lshl_b32 s75, s72, 7
    v_lshl_add_u32 v121, v1, 2, v121
    v_add_u32 v121, s75, v121
    v_lshl_add_u32 v122, v7, 5, v1
    v_add_u32 v122, s73, v122
    v_lshlrev_b32 v122, 1, v122
    s_movk_i32 s66, 0x1000
    s_waitcnt lgkmcnt(0)
    s_mov_b32 s24, s4
    s_mov_b32 s25, s5
    s_mov_b32 s26, 2097152
    s_mov_b32 s27, 0x20000
    s_mov_b32 s28, s6
    s_mov_b32 s29, s7
    s_mov_b32 s30, 2097152
    s_mov_b32 s31, 0x20000
    s_mov_b32 s32, s8
    s_mov_b32 s33, s9
    s_mov_b32 s34, 2097152
    s_mov_b32 s35, 0x20000
    s_mov_b32 s36, s10
    s_mov_b32 s37, s11
    s_mov_b32 s38, 4096
    s_mov_b32 s39, 0x20000
    buffer_load_dwordx4 v[36:39], v6, s[36:39], 0 offen
    buffer_load_dword v8, v5, s[28:31], 0 offen offset:0
    buffer_load_dword v9, v5, s[28:31], 0 offen offset:1024
    buffer_load_dword v10, v5, s[28:31], 0 offen offset:2048
    buffer_load_dword v11, v4, s[28:31], 0 offen offset:0
    buffer_load_dword v12, v4, s[28:31], 0 offen offset:1024
    buffer_load_dword v13, v4, s[28:31], 0 offen offset:2048
    buffer_load_dword v14, v4, s[28:31], 0 offen offset:3072
    buffer_load_dword v15, v4, s[28:31], s66 offen offset:0
    buffer_load_dword v16, v4, s[28:31], s66 offen offset:1024
    buffer_load_dword v17, v4, s[28:31], s66 offen offset:2048
    buffer_load_dword v18, v4, s[28:31], s66 offen offset:3072
    buffer_load_dword v19, v4, s[32:35], 0 offen offset:0
    buffer_load_dword v20, v4, s[32:35], 0 offen offset:1024
    buffer_load_dword v21, v4, s[32:35], 0 offen offset:2048
    buffer_load_dword v22, v4, s[32:35], 0 offen offset:3072
    buffer_load_dword v23, v4, s[32:35], s66 offen offset:0
    buffer_load_dword v24, v4, s[32:35], s66 offen offset:1024
    buffer_load_dword v25, v4, s[32:35], s66 offen offset:2048
    buffer_load_dword v26, v4, s[32:35], s66 offen offset:3072
    s_mov_b32 s76, s16
    s_mov_b32 s77, s17
    s_mov_b32 s78, 1024
    s_mov_b32 s79, 0x20000
    s_mov_b32 s40, s18
    s_mov_b32 s41, s19
    s_cmp_lt_u32 s2, 192
    s_cselect_b32 s42, 3145728, 0
    s_mov_b32 s43, 0x20000
    buffer_load_ushort v123, v122, s[76:79], 0 offen
    buffer_load_dword v27, v4, s[24:27], 0 offen offset:0
    buffer_load_dword v28, v4, s[24:27], 0 offen offset:1024
    buffer_load_dword v29, v4, s[24:27], 0 offen offset:2048
    buffer_load_dword v30, v4, s[24:27], 0 offen offset:3072
    buffer_load_dword v31, v4, s[24:27], s66 offen offset:0
    buffer_load_dword v32, v4, s[24:27], s66 offen offset:1024
    buffer_load_dword v33, v4, s[24:27], s66 offen offset:2048
    buffer_load_dword v34, v4, s[24:27], s66 offen offset:3072
    buffer_load_dwordx4 v[40:43], v120, s[24:27], 0 offen
    buffer_load_dwordx4 v[44:47], v120, s[24:27], 0 offen offset:1024
    buffer_load_dword v124, v121, s[40:43], 0 offen
    s_mov_b32 s62, 6144
    buffer_load_dword v125, v121, s[40:43], s62 offen
    s_mov_b32 s62, 12288
    buffer_load_dword v126, v121, s[40:43], s62 offen
    s_mov_b32 s62, 18432
    buffer_load_dword v127, v121, s[40:43], s62 offen
    s_mov_b32 s62, 24576
    buffer_load_dword v128, v121, s[40:43], s62 offen
    s_mov_b32 s62, 30720
    buffer_load_dword v129, v121, s[40:43], s62 offen
    s_mov_b32 s62, 36864
    buffer_load_dword v130, v121, s[40:43], s62 offen
    s_mov_b32 s62, 43008
    buffer_load_dword v131, v121, s[40:43], s62 offen
    s_mov_b32 s62, 49152
    buffer_load_dword v132, v121, s[40:43], s62 offen
    s_mov_b32 s62, 55296
    buffer_load_dword v133, v121, s[40:43], s62 offen
    s_mov_b32 s62, 61440
    buffer_load_dword v134, v121, s[40:43], s62 offen
    s_mov_b32 s62, 67584
    buffer_load_dword v135, v121, s[40:43], s62 offen
    s_mov_b32 s62, 73728
    buffer_load_dword v136, v121, s[40:43], s62 offen
    s_mov_b32 s62, 79872
    buffer_load_dword v137, v121, s[40:43], s62 offen
    s_mov_b32 s62, 86016
    buffer_load_dword v138, v121, s[40:43], s62 offen
    s_mov_b32 s62, 92160
    buffer_load_dword v139, v121, s[40:43], s62 offen
    s_mov_b32 s52, s12
    s_mov_b32 s53, s13
    s_mov_b32 s54, 2097152
    s_mov_b32 s55, 0x20000
    buffer_load_dwordx4 v[48:51], v119, s[52:55], 0 offen
    buffer_load_dwordx4 v[52:55], v119, s[52:55], s66 offen
    s_mov_b32 s12, s20
    s_mov_b32 s13, s21
    s_mov_b32 s14, 2097152
    s_mov_b32 s15, 0x20000
    s_add_u32 s44, s20, 2097152
    s_addc_u32 s45, s21, 0
    s_mov_b32 s46, 2097152
    s_mov_b32 s47, 0x20000
    s_add_u32 s48, s20, 6291456
    s_addc_u32 s49, s21, 0
    s_mov_b32 s50, 16384
    s_mov_b32 s51, 0x20000
    s_lshl_b32 s62, s59, 18
    v_lshlrev_b32 v6, 13, v1
    v_add_u32 v6, s62, v6
    v_lshl_add_u32 v6, v3, 1, v6
    s_mov_b32 s67, 0x05040100
    s_mov_b32 s68, 0x07060302
    s_waitcnt vmcnt(37)
    v_lshlrev_b32 v94, 16, v36
    v_lshlrev_b32 v95, 16, v38
    v_and_b32 v96, 0xffff0000, v36
    v_and_b32 v97, 0xffff0000, v38
    v_lshlrev_b32 v98, 16, v37
    v_lshlrev_b32 v99, 16, v39
    v_and_b32 v100, 0xffff0000, v37
    v_and_b32 v101, 0xffff0000, v39
    v_lshlrev_b32 v56, 16, v8
    v_and_b32 v57, 0xffff0000, v8
    v_lshlrev_b32 v58, 16, v9
    v_and_b32 v59, 0xffff0000, v9
    v_lshlrev_b32 v60, 16, v10
    v_and_b32 v61, 0xffff0000, v10
    v_lshlrev_b32 v62, 16, v11
    v_and_b32 v63, 0xffff0000, v11
    v_lshlrev_b32 v64, 16, v12
    v_and_b32 v65, 0xffff0000, v12
    v_lshlrev_b32 v66, 16, v13
    v_and_b32 v67, 0xffff0000, v13
    v_lshlrev_b32 v68, 16, v14
    v_and_b32 v69, 0xffff0000, v14
    v_lshlrev_b32 v70, 16, v15
    v_and_b32 v71, 0xffff0000, v15
    v_lshlrev_b32 v72, 16, v16
    v_and_b32 v73, 0xffff0000, v16
    v_lshlrev_b32 v74, 16, v17
    v_and_b32 v75, 0xffff0000, v17
    v_lshlrev_b32 v76, 16, v18
    v_and_b32 v77, 0xffff0000, v18
    v_pk_mul_f32 v[102:103], v[62:63], v[94:95]
    v_pk_fma_f32 v[102:103], v[60:61], v[96:97], v[102:103]
    v_pk_fma_f32 v[102:103], v[58:59], v[98:99], v[102:103]
    v_pk_fma_f32 v[102:103], v[56:57], v[100:101], v[102:103]
    v_pk_mul_f32 v[104:105], v[64:65], v[94:95]
    v_pk_fma_f32 v[104:105], v[62:63], v[96:97], v[104:105]
    v_pk_fma_f32 v[104:105], v[60:61], v[98:99], v[104:105]
    v_pk_fma_f32 v[104:105], v[58:59], v[100:101], v[104:105]
    v_pk_mul_f32 v[106:107], v[66:67], v[94:95]
    v_pk_fma_f32 v[106:107], v[64:65], v[96:97], v[106:107]
    v_pk_fma_f32 v[106:107], v[62:63], v[98:99], v[106:107]
    v_pk_fma_f32 v[106:107], v[60:61], v[100:101], v[106:107]
    v_pk_mul_f32 v[108:109], v[68:69], v[94:95]
    v_pk_fma_f32 v[108:109], v[66:67], v[96:97], v[108:109]
    v_pk_fma_f32 v[108:109], v[64:65], v[98:99], v[108:109]
    v_pk_fma_f32 v[108:109], v[62:63], v[100:101], v[108:109]
    v_pk_mul_f32 v[110:111], v[70:71], v[94:95]
    v_pk_fma_f32 v[110:111], v[68:69], v[96:97], v[110:111]
    v_pk_fma_f32 v[110:111], v[66:67], v[98:99], v[110:111]
    v_pk_fma_f32 v[110:111], v[64:65], v[100:101], v[110:111]
    v_pk_mul_f32 v[112:113], v[72:73], v[94:95]
    v_pk_fma_f32 v[112:113], v[70:71], v[96:97], v[112:113]
    v_pk_fma_f32 v[112:113], v[68:69], v[98:99], v[112:113]
    v_pk_fma_f32 v[112:113], v[66:67], v[100:101], v[112:113]
    v_pk_mul_f32 v[114:115], v[74:75], v[94:95]
    v_pk_fma_f32 v[114:115], v[72:73], v[96:97], v[114:115]
    v_pk_fma_f32 v[114:115], v[70:71], v[98:99], v[114:115]
    v_pk_fma_f32 v[114:115], v[68:69], v[100:101], v[114:115]
    v_pk_mul_f32 v[116:117], v[76:77], v[94:95]
    v_pk_fma_f32 v[116:117], v[74:75], v[96:97], v[116:117]
    v_pk_fma_f32 v[116:117], v[72:73], v[98:99], v[116:117]
    v_pk_fma_f32 v[116:117], v[70:71], v[100:101], v[116:117]
    s_waitcnt vmcnt(29)
    v_lshlrev_b32 v78, 16, v19
    v_and_b32 v79, 0xffff0000, v19
    v_lshlrev_b32 v80, 16, v20
    v_and_b32 v81, 0xffff0000, v20
    v_lshlrev_b32 v82, 16, v21
    v_and_b32 v83, 0xffff0000, v21
    v_lshlrev_b32 v84, 16, v22
    v_and_b32 v85, 0xffff0000, v22
    v_lshlrev_b32 v86, 16, v23
    v_and_b32 v87, 0xffff0000, v23
    v_lshlrev_b32 v88, 16, v24
    v_and_b32 v89, 0xffff0000, v24
    v_lshlrev_b32 v90, 16, v25
    v_and_b32 v91, 0xffff0000, v25
    v_lshlrev_b32 v92, 16, v26
    v_and_b32 v93, 0xffff0000, v26
    v_pk_mul_f32 v[102:103], v[102:103], v[78:79]
    v_pk_mul_f32 v[104:105], v[104:105], v[80:81]
    v_pk_mul_f32 v[106:107], v[106:107], v[82:83]
    v_pk_mul_f32 v[108:109], v[108:109], v[84:85]
    v_pk_mul_f32 v[110:111], v[110:111], v[86:87]
    v_pk_mul_f32 v[112:113], v[112:113], v[88:89]
    v_pk_mul_f32 v[114:115], v[114:115], v[90:91]
    v_pk_mul_f32 v[116:117], v[116:117], v[92:93]
    v_cvt_pk_bf16_f32 v56, v108, v106
    v_cvt_pk_bf16_f32 v57, v104, v102
    v_cvt_pk_bf16_f32 v58, v116, v114
    v_cvt_pk_bf16_f32 v59, v112, v110
    v_cvt_pk_bf16_f32 v60, v109, v107
    v_cvt_pk_bf16_f32 v61, v105, v103
    v_cvt_pk_bf16_f32 v62, v117, v115
    v_cvt_pk_bf16_f32 v63, v113, v111
    v_mul_u32_u24 v141, 288, v1
    v_lshl_add_u32 v141, v2, 4, v141
    ds_write_b128 v141, v[56:59] offset:2048
    ds_write_b128 v141, v[60:63] offset:2192
    v_lshrrev_b32 v142, 3, v0
    v_and_b32 v143, 7, v0
    v_lshlrev_b32 v144, 12, v142
    v_mul_u32_u24 v142, 144, v142
    v_lshl_add_u32 v142, v143, 4, v142
    v_lshl_add_u32 v143, v143, 4, v144
    s_lshl_b32 s62, s59, 18
    s_lshl_b32 s22, s60, 1
    s_add_u32 s62, s62, s22
    v_add_u32 v143, s62, v143
    s_mov_b32 s23, 0x20000
    s_waitcnt lgkmcnt(0)
    s_barrier
    ds_read_b128 v[56:59], v142 offset:2048
    ds_read_b128 v[60:63], v142 offset:6656
    s_waitcnt lgkmcnt(0)
    buffer_store_dwordx4 v[56:59], v143, s[12:15], 0 offen sc1
    buffer_store_dwordx4 v[60:63], v143, s[12:15], s23 offen sc1
    s_waitcnt vmcnt(30)
    v_lshlrev_b32 v123, 16, v123
    v_mul_f32 v8, 0xbfb8aa3b, v123
    v_exp_f32 v8, v8
    s_nop 0
    v_add_f32 v8, 1.0, v8
    v_rcp_f32 v8, v8
    s_nop 0
    v_mul_f32 v123, v123, v8
    v_cvt_pk_bf16_f32 v123, v123, v123
    v_lshlrev_b32 v123, 16, v123
    v_lshlrev_b32 v8, 7, v7
    v_lshl_add_u32 v9, v1, 2, v8
    ds_write_b32 v9, v123
    v_lshrrev_b32 v140, 5, v35
    v_lshl_add_u32 v140, v140, 6, v8
    s_waitcnt vmcnt(22)
    v_perm_b32 v64, v28, v27, s67
    v_perm_b32 v65, v30, v29, s67
    v_perm_b32 v66, v32, v31, s67
    v_perm_b32 v67, v34, v33, s67
    v_perm_b32 v68, v28, v27, s68
    v_perm_b32 v69, v30, v29, s68
    v_perm_b32 v70, v32, v31, s68
    v_perm_b32 v71, v34, v33, s68
    ds_write_b128 v141, v[64:67] offset:11264
    ds_write_b128 v141, v[68:71] offset:11408
    s_waitcnt lgkmcnt(0)
    s_barrier
    ds_read_b128 v[64:67], v142 offset:11264
    ds_read_b128 v[68:71], v142 offset:15872
    s_waitcnt lgkmcnt(0)
    buffer_store_dwordx4 v[64:67], v143, s[44:47], 0 offen sc1
    buffer_store_dwordx4 v[68:71], v143, s[44:47], s23 offen sc1
    s_waitcnt lgkmcnt(0)
    ds_read_b128 v[8:11], v140
    ds_read_b128 v[12:15], v140 offset:16
    ds_read_b128 v[16:19], v140 offset:32
    ds_read_b128 v[20:23], v140 offset:48
    s_waitcnt vmcnt(22)
    v_mov_b32 v72, 0
    v_mov_b32 v73, 0
    v_mov_b32 v74, 0
    v_mov_b32 v75, 0
    s_mov_b32 s69, 0x3f803f80
    v_dot2c_f32_bf16 v72, s69, v40
    v_dot2c_f32_bf16 v73, v40, v40
    v_dot2c_f32_bf16 v74, s69, v44
    v_dot2c_f32_bf16 v75, v44, v44
    v_dot2c_f32_bf16 v72, s69, v41
    v_dot2c_f32_bf16 v73, v41, v41
    v_dot2c_f32_bf16 v74, s69, v45
    v_dot2c_f32_bf16 v75, v45, v45
    v_dot2c_f32_bf16 v72, s69, v42
    v_dot2c_f32_bf16 v73, v42, v42
    v_dot2c_f32_bf16 v74, s69, v46
    v_dot2c_f32_bf16 v75, v46, v46
    v_dot2c_f32_bf16 v72, s69, v43
    v_dot2c_f32_bf16 v73, v43, v43
    v_dot2c_f32_bf16 v74, s69, v47
    v_dot2c_f32_bf16 v75, v47, v47
    v_add_f32_dpp v72, v72, v72 row_shr:1 row_mask:0xf bank_mask:0xf bound_ctrl:0
    v_add_f32_dpp v73, v73, v73 row_shr:1 row_mask:0xf bank_mask:0xf bound_ctrl:0
    v_add_f32_dpp v74, v74, v74 row_shr:1 row_mask:0xf bank_mask:0xf bound_ctrl:0
    v_add_f32_dpp v75, v75, v75 row_shr:1 row_mask:0xf bank_mask:0xf bound_ctrl:0
    v_add_f32_dpp v72, v72, v72 row_shr:2 row_mask:0xf bank_mask:0xf bound_ctrl:0
    v_add_f32_dpp v73, v73, v73 row_shr:2 row_mask:0xf bank_mask:0xf bound_ctrl:0
    v_add_f32_dpp v74, v74, v74 row_shr:2 row_mask:0xf bank_mask:0xf bound_ctrl:0
    v_add_f32_dpp v75, v75, v75 row_shr:2 row_mask:0xf bank_mask:0xf bound_ctrl:0
    v_add_f32_dpp v72, v72, v72 row_shr:4 row_mask:0xf bank_mask:0xf bound_ctrl:0
    v_add_f32_dpp v73, v73, v73 row_shr:4 row_mask:0xf bank_mask:0xf bound_ctrl:0
    v_add_f32_dpp v74, v74, v74 row_shr:4 row_mask:0xf bank_mask:0xf bound_ctrl:0
    v_add_f32_dpp v75, v75, v75 row_shr:4 row_mask:0xf bank_mask:0xf bound_ctrl:0
    v_add_f32_dpp v72, v72, v72 row_shr:8 row_mask:0xf bank_mask:0xf bound_ctrl:0
    v_add_f32_dpp v73, v73, v73 row_shr:8 row_mask:0xf bank_mask:0xf bound_ctrl:0
    v_add_f32_dpp v74, v74, v74 row_shr:8 row_mask:0xf bank_mask:0xf bound_ctrl:0
    v_add_f32_dpp v75, v75, v75 row_shr:8 row_mask:0xf bank_mask:0xf bound_ctrl:0
    v_add_f32_dpp v72, v72, v72 row_bcast:15 row_mask:0xa bank_mask:0xf
    v_add_f32_dpp v73, v73, v73 row_bcast:15 row_mask:0xa bank_mask:0xf
    v_add_f32_dpp v74, v74, v74 row_bcast:15 row_mask:0xa bank_mask:0xf
    v_add_f32_dpp v75, v75, v75 row_bcast:15 row_mask:0xa bank_mask:0xf
    v_add_f32_dpp v72, v72, v72 row_bcast:31 row_mask:0xc bank_mask:0xf
    v_add_f32_dpp v73, v73, v73 row_bcast:31 row_mask:0xc bank_mask:0xf
    v_add_f32_dpp v74, v74, v74 row_bcast:31 row_mask:0xc bank_mask:0xf
    v_add_f32_dpp v75, v75, v75 row_bcast:31 row_mask:0xc bank_mask:0xf
    v_mul_f32 v72, 0x3b000000, v72
    v_mul_f32 v74, 0x3b000000, v74
    v_mul_f32 v73, 0x3b000000, v73
    v_mul_f32 v75, 0x3b000000, v75
    v_fma_f32 v73, -v72, v72, v73
    v_fma_f32 v75, -v74, v74, v75
    v_max_f32 v73, 0, v73
    v_max_f32 v75, 0, v75
    v_add_f32 v73, 0x3727c5ac, v73
    v_add_f32 v75, 0x3727c5ac, v75
    v_rsq_f32 v76, v73
    v_rsq_f32 v77, v75
    s_nop 0
    v_mul_f32 v78, v72, v76
    v_mul_f32 v79, v74, v77
    s_mov_b32 exec_lo, 0
    s_mov_b32 exec_hi, 0x80000000
    s_movk_i32 s70, 0x2000
    buffer_store_dwordx2 v[76:77], v118, s[48:51], 0 offen sc1
    buffer_store_dwordx2 v[78:79], v118, s[48:51], s70 offen sc1
    s_mov_b64 exec, -1
    s_cmp_ge_u32 s2, 192
    s_cbranch_scc1 k1_end
    v_mov_b32 v40, 0
    v_mov_b32 v41, 0
    s_waitcnt vmcnt(8) lgkmcnt(0)
    v_lshlrev_b32 v42, 16, v124
    v_and_b32 v43, 0xffff0000, v124
    v_fmac_f32 v40, v42, v8
    v_fmac_f32 v41, v43, v8
    v_lshlrev_b32 v42, 16, v125
    v_and_b32 v43, 0xffff0000, v125
    v_fmac_f32 v40, v42, v9
    v_fmac_f32 v41, v43, v9
    v_lshlrev_b32 v42, 16, v126
    v_and_b32 v43, 0xffff0000, v126
    v_fmac_f32 v40, v42, v10
    v_fmac_f32 v41, v43, v10
    v_lshlrev_b32 v42, 16, v127
    v_and_b32 v43, 0xffff0000, v127
    v_fmac_f32 v40, v42, v11
    v_fmac_f32 v41, v43, v11
    v_lshlrev_b32 v42, 16, v128
    v_and_b32 v43, 0xffff0000, v128
    v_fmac_f32 v40, v42, v12
    v_fmac_f32 v41, v43, v12
    v_lshlrev_b32 v42, 16, v129
    v_and_b32 v43, 0xffff0000, v129
    v_fmac_f32 v40, v42, v13
    v_fmac_f32 v41, v43, v13
    v_lshlrev_b32 v42, 16, v130
    v_and_b32 v43, 0xffff0000, v130
    v_fmac_f32 v40, v42, v14
    v_fmac_f32 v41, v43, v14
    v_lshlrev_b32 v42, 16, v131
    v_and_b32 v43, 0xffff0000, v131
    v_fmac_f32 v40, v42, v15
    v_fmac_f32 v41, v43, v15
    v_lshlrev_b32 v42, 16, v132
    v_and_b32 v43, 0xffff0000, v132
    v_fmac_f32 v40, v42, v16
    v_fmac_f32 v41, v43, v16
    v_lshlrev_b32 v42, 16, v133
    v_and_b32 v43, 0xffff0000, v133
    v_fmac_f32 v40, v42, v17
    v_fmac_f32 v41, v43, v17
    v_lshlrev_b32 v42, 16, v134
    v_and_b32 v43, 0xffff0000, v134
    v_fmac_f32 v40, v42, v18
    v_fmac_f32 v41, v43, v18
    v_lshlrev_b32 v42, 16, v135
    v_and_b32 v43, 0xffff0000, v135
    v_fmac_f32 v40, v42, v19
    v_fmac_f32 v41, v43, v19
    v_lshlrev_b32 v42, 16, v136
    v_and_b32 v43, 0xffff0000, v136
    v_fmac_f32 v40, v42, v20
    v_fmac_f32 v41, v43, v20
    v_lshlrev_b32 v42, 16, v137
    v_and_b32 v43, 0xffff0000, v137
    v_fmac_f32 v40, v42, v21
    v_fmac_f32 v41, v43, v21
    v_lshlrev_b32 v42, 16, v138
    v_and_b32 v43, 0xffff0000, v138
    v_fmac_f32 v40, v42, v22
    v_fmac_f32 v41, v43, v22
    v_lshlrev_b32 v42, 16, v139
    v_and_b32 v43, 0xffff0000, v139
    v_fmac_f32 v40, v42, v23
    v_fmac_f32 v41, v43, v23
    v_mov_b32 v42, v40
    v_mov_b32 v43, v41
    s_nop 0
    v_permlane32_swap_b32 v40, v42
    v_permlane32_swap_b32 v41, v43
    v_add_f32 v40, v40, v42
    v_add_f32 v41, v41, v43
    v_lshlrev_b32 v5, 8, v7
    v_lshl_add_u32 v5, v1, 3, v5
    ds_write_b64 v5, v[40:41] offset:1024
    s_waitcnt lgkmcnt(0)
    s_barrier
    v_lshlrev_b32 v5, 2, v0
    v_cmp_gt_u32 vcc, 64, v0
    s_nop 3
    s_and_saveexec_b64 s[64:65], vcc
    s_cbranch_execz k1_end
    ds_read_b32 v8, v5 offset:1024
    ds_read_b32 v9, v5 offset:1280
    ds_read_b32 v10, v5 offset:1536
    ds_read_b32 v11, v5 offset:1792
    s_add_u32 s32, s20, 6307840
    s_addc_u32 s33, s21, 0
    s_mov_b32 s34, 49152
    s_mov_b32 s35, 0x20000
    s_mul_i32 s59, s71, 12288
    s_lshl_b32 s61, s72, 8
    s_add_u32 s59, s59, s61
    s_waitcnt lgkmcnt(0)
    v_add_f32 v8, v8, v9
    v_add_f32 v10, v10, v11
    v_add_f32 v8, v8, v10
    buffer_store_dword v8, v5, s[32:35], s59 offen sc1
k1_end:
    s_mov_b64 exec, -1
    s_add_u32 s32, s20, 6815744
    s_addc_u32 s33, s21, 0
    s_mov_b32 s34, 65536
    s_mov_b32 s35, 0x20000
    s_add_u32 s36, s20, 6946816
    s_addc_u32 s37, s21, 0
    s_mov_b32 s38, 16384
    s_mov_b32 s39, 0x20000
    v_mov_b32 v8, 0
    v_mov_b32 v9, 0
    v_mov_b32 v10, 0
    v_mov_b32 v11, 0
    v_mov_b32 v12, -1.0
    v_mov_b32 v13, -1.0
    v_mov_b32 v14, -1.0
    v_mov_b32 v15, -1.0
    v_lshlrev_b32 v5, 4, v0
    s_lshl_b32 s59, s2, 8
    s_lshl_b32 s60, s2, 6
    v_cmp_gt_u32 vcc, 16, v0
    s_nop 3
    s_and_saveexec_b64 s[64:65], vcc
    s_cbranch_execz k1_end2
    buffer_store_dwordx4 v[8:11], v5, s[32:35], s59 offen sc1
    v_cmp_gt_u32 vcc, 4, v0
    s_nop 3
    s_and_b64 exec, exec, vcc
    buffer_store_dwordx4 v[12:15], v5, s[36:39], s60 offen sc1
k1_end2:
    s_mov_b64 exec, -1
    s_add_u32 s32, s20, 6422528
    s_addc_u32 s33, s21, 0
    s_mov_b32 s34, 14336
    s_mov_b32 s35, 0x20000
    s_lshl_b32 s59, s2, 8
    v_cmp_gt_u32 vcc, 16, v0
    s_nop 3
    s_and_saveexec_b64 s[64:65], vcc
    s_cbranch_execz k1_end4
    buffer_store_dwordx4 v[8:11], v5, s[32:35], s59 offen sc1
k1_end4:
    s_mov_b64 exec, -1
    s_endpgm
k1_done:
    s_endpgm
.globl k2_conv_kernel
.p2align 8
.type k2_conv_kernel,@function
k2_conv_kernel:
    s_load_dwordx4 s[4:7], s[0:1], 32
    s_load_dwordx2 s[8:9], s[0:1], 104
    s_getpc_b64 s[24:25]
cp_3:
    s_add_u32 s24, s24, k2_top_end-cp_3
    s_addc_u32 s25, s25, 0
    s_mov_b32 s26, k2_done-k2_top_end
    s_mov_b32 s27, 0x20000
    v_mbcnt_lo_u32_b32 v195, -1, 0
    v_mbcnt_hi_u32_b32 v195, -1, v195
    v_lshlrev_b32 v195, 7, v195
    buffer_load_dword v196, v195, s[24:27], 0 offen
k2_top_end:
    s_cmp_ge_u32 s2, 480
    s_cbranch_scc1 k2_done
    s_cmp_ge_u32 s2, 256
    s_cbranch_scc1 k2_side
    s_setprio 3
    v_lshrrev_b32 v1, 6, v0
    v_and_b32 v2, 63, v0
    v_readfirstlane_b32 s10, v1
    s_nop 3
    s_lshr_b32 s11, s10, 1
    s_and_b32 s12, s10, 1
    s_lshl_b32 s13, s2, 1
    s_add_u32 s13, s13, s11
    s_lshl_b32 s14, s13, 12
    v_and_b32 v3, 15, v2
    v_lshrrev_b32 v4, 4, v2
    s_waitcnt lgkmcnt(0)
    s_add_u32 s16, s4, s14
    s_addc_u32 s17, s5, 0
    s_mov_b32 s18, 4096
    s_mov_b32 s19, 0x20000
    s_add_u32 s20, s8, s14
    s_addc_u32 s21, s9, 0
    s_mov_b32 s22, 4096
    s_mov_b32 s23, 0x20000
    s_lshl_b32 s15, s12, 11
    v_lshlrev_b32 v5, 4, v2
    v_add_u32 v5, s15, v5
    v_subrev_u32 v6, 8, v5
    buffer_load_dwordx2 v[8:9], v6, s[16:19], 0 offen
    buffer_load_dwordx4 v[10:13], v5, s[16:19], 0 offen
    buffer_load_dwordx2 v[14:15], v6, s[16:19], 0 offen offset:1024
    buffer_load_dwordx4 v[16:19], v5, s[16:19], 0 offen offset:1024
    s_mul_i32 s36, s11, 4608
    s_add_u32 s36, s36, 33280
    s_lshl_b32 s37, s12, 11
    s_add_u32 s38, s36, s37
    s_add_u32 s38, s38, 512
    v_lshlrev_b32 v7, 4, v2
    v_add_u32 v7, s37, v7
    s_mov_b32 m0, s38
    s_nop 0
    buffer_load_dwordx4 v7, s[20:23], 0 offen lds
    s_add_u32 s38, s38, 1024
    s_mov_b32 m0, s38
    s_nop 0
    v_add_u32 v20, 1024, v7
    buffer_load_dwordx4 v20, s[20:23], 0 offen lds
    s_cmp_ge_u32 s2, 8
    s_cbranch_scc1 k2_nopf
    s_getpc_b64 s[24:25]
cp_4:
    s_add_u32 s24, s24, k2_pf_start-cp_4
    s_addc_u32 s25, s25, 0
    s_mov_b32 s26, k2_done-k2_pf_start
    s_mov_b32 s27, 0x20000
    v_mbcnt_lo_u32_b32 v195, -1, 0
    v_mbcnt_hi_u32_b32 v195, -1, v195
    v_lshlrev_b32 v195, 7, v195
    buffer_load_dword v196, v195, s[24:27], 0 offen
k2_nopf:
k2_pf_start:
    s_add_u32 s24, s8, 2097152
    s_addc_u32 s25, s9, 0
    s_add_u32 s24, s24, s14
    s_addc_u32 s25, s25, 0
    s_mov_b32 s26, 4096
    s_mov_b32 s27, 0x20000
    s_add_u32 s28, s8, 4194304
    s_addc_u32 s29, s9, 0
    s_add_u32 s28, s28, s14
    s_addc_u32 s29, s29, 0
    s_mov_b32 s30, 4096
    s_mov_b32 s31, 0x20000
    s_add_u32 s32, s8, 6291456
    s_addc_u32 s33, s9, 0
    s_mov_b32 s34, 0x4000
    s_mov_b32 s35, 0x20000
    v_lshlrev_b32 v192, 4, v3
    v_lshl_add_u32 v192, v4, 2, v192
    s_lshl_b32 s39, s12, 9
    v_add_u32 v192, s39, v192
    v_lshlrev_b32 v193, 1, v192
    v_lshlrev_b32 v194, 2, v192
    s_movk_i32 s40, 0x2000
    s_movk_i32 s66, 0x1000
    s_movk_i32 s67, 0x3000
    buffer_load_dwordx2 v[200:201], v193, s[24:27], 0 offen offset:0
    buffer_load_dwordx2 v[202:203], v193, s[24:27], 0 offen offset:512
    buffer_load_dwordx2 v[204:205], v193, s[24:27], 0 offen offset:2048
    buffer_load_dwordx2 v[206:207], v193, s[24:27], 0 offen offset:2560
    buffer_load_dwordx4 v[208:211], v194, s[32:35], 0 offen offset:0
    buffer_load_dwordx4 v[224:227], v194, s[32:35], s40 offen offset:0
    buffer_load_dwordx4 v[212:215], v194, s[32:35], 0 offen offset:1024
    buffer_load_dwordx4 v[228:231], v194, s[32:35], s40 offen offset:1024
    buffer_load_dwordx4 v[216:219], v194, s[32:35], s66 offen offset:0
    buffer_load_dwordx4 v[232:235], v194, s[32:35], s67 offen offset:0
    buffer_load_dwordx4 v[220:223], v194, s[32:35], s66 offen offset:1024
    buffer_load_dwordx4 v[236:239], v194, s[32:35], s67 offen offset:1024
    s_lshl_b32 s41, s13, 2
    s_add_u32 s42, s8, 6307840
    s_addc_u32 s43, s9, 0
    s_add_u32 s42, s42, s41
    s_addc_u32 s43, s43, 0
    s_load_dword s44, s[42:43], 0
    s_load_dword s45, s[42:43], 12288
    s_load_dword s46, s[42:43], 24576
    s_load_dword s47, s[42:43], 36864
    s_load_dword s48, s[42:43], 2048
    s_load_dword s49, s[42:43], 14336
    s_load_dword s50, s[42:43], 26624
    s_load_dword s51, s[42:43], 38912
    s_load_dword s52, s[42:43], 4096
    s_load_dword s53, s[42:43], 16384
    s_load_dword s54, s[42:43], 28672
    s_load_dword s55, s[42:43], 40960
    s_lshl_b32 s41, s2, 2
    s_add_u32 s6, s6, s41
    s_addc_u32 s7, s7, 0
    s_load_dword s56, s[6:7], 0
    v_mov_b32 v24, 0
    v_mov_b32 v25, 0
    v_mov_b32 v26, 0
    v_mov_b32 v27, 0
    s_mul_i32 s57, s11, 16640
    v_lshlrev_b32 v28, 4, v2
    v_add_u32 v28, s36, v28
    v_subrev_u32 v29, 32, v2
    v_lshrrev_b32 v30, 1, v29
    v_mul_u32_u24 v30, 4160, v30
    v_and_b32 v29, 1, v2
    v_lshl_add_u32 v30, v29, 4, v30
    v_add_u32 v30, s57, v30
    v_cmp_gt_u32 vcc, 32, v2
    s_nop 1
    v_cndmask_b32 v28, v30, v28, vcc
    v_cmp_gt_u32 vcc, 40, v2
    s_cmp_eq_u32 s12, 0
    s_nop 2
    s_cselect_b64 s[58:59], vcc, 0
    s_mov_b64 exec, s[58:59]
    s_cbranch_execz k2_nozero
    ds_write_b128 v28, v[24:27]
k2_nozero:
    s_mov_b64 exec, -1
    s_waitcnt vmcnt(14)
    v_add_u32 v31, s57, v5
    v_cmp_eq_u32 vcc, 0, v5
    s_nop 1
    v_cndmask_b32 v8, v8, v24, vcc
    v_cndmask_b32 v9, v9, v24, vcc
    ds_write_b128 v31, v[10:13] offset:12512
    v_mov_b32 v32, v9
    v_mov_b32 v33, v10
    v_mov_b32 v34, v11
    v_mov_b32 v35, v12
    ds_write_b128 v31, v[32:35] offset:4192
    v_alignbit_b32 v36, v9, v8, 16
    v_alignbit_b32 v37, v10, v9, 16
    v_alignbit_b32 v38, v11, v10, 16
    v_alignbit_b32 v39, v12, v11, 16
    ds_write_b128 v31, v[36:39] offset:32
    v_alignbit_b32 v40, v10, v9, 16
    v_alignbit_b32 v41, v11, v10, 16
    v_alignbit_b32 v42, v12, v11, 16
    v_alignbit_b32 v43, v13, v12, 16
    ds_write_b128 v31, v[40:43] offset:8352
    ds_write_b128 v31, v[16:19] offset:13536
    v_mov_b32 v32, v15
    v_mov_b32 v33, v16
    v_mov_b32 v34, v17
    v_mov_b32 v35, v18
    ds_write_b128 v31, v[32:35] offset:5216
    v_alignbit_b32 v36, v15, v14, 16
    v_alignbit_b32 v37, v16, v15, 16
    v_alignbit_b32 v38, v17, v16, 16
    v_alignbit_b32 v39, v18, v17, 16
    ds_write_b128 v31, v[36:39] offset:1056
    v_alignbit_b32 v40, v16, v15, 16
    v_alignbit_b32 v41, v17, v16, 16
    v_alignbit_b32 v42, v18, v17, 16
    v_alignbit_b32 v43, v19, v18, 16
    ds_write_b128 v31, v[40:43] offset:9376
    s_lshl_b32 s60, s12, 6
    s_sub_u32 s61, s36, s60
    s_add_u32 s61, s61, 96
    v_lshlrev_b32 v44, 5, v3
    v_lshl_add_u32 v44, v4, 4, v44
    v_add_u32 v44, s61, v44
    s_add_u32 s62, s57, s60
    s_add_u32 s62, s62, 56
    v_and_b32 v45, 3, v3
    v_mul_u32_u24 v45, 4160, v45
    v_lshrrev_b32 v46, 2, v3
    v_lshl_add_u32 v45, v46, 3, v45
    v_lshlrev_b32 v46, 4, v4
    v_sub_u32 v45, v45, v46
    v_add_u32 v45, s62, v45
    s_waitcnt vmcnt(12) lgkmcnt(0)
    s_barrier
    v_mov_b32 v240, s44
    v_add_f32 v240, s45, v240
    v_add_f32 v240, s46, v240
    v_add_f32 v240, s47, v240
    v_mov_b32 v241, s48
    v_add_f32 v241, s49, v241
    v_add_f32 v241, s50, v241
    v_add_f32 v241, s51, v241
    v_mov_b32 v242, s52
    v_add_f32 v242, s53, v242
    v_add_f32 v242, s54, v242
    v_add_f32 v242, s55, v242
    v_cvt_pk_bf16_f32 v240, v240, v240
    v_lshlrev_b32 v240, 16, v240
    v_cvt_pk_bf16_f32 v241, v241, v241
    v_lshlrev_b32 v241, 16, v241
    v_cvt_pk_bf16_f32 v242, v242, v242
    v_lshlrev_b32 v242, 16, v242
    v_add_f32 v241, 1.0, v241
    v_cvt_pk_bf16_f32 v241, v241, v241
    v_lshlrev_b32 v241, 16, v241
    v_mov_b32 v243, v242
    s_lshl_b32 s65, s11, 4
    s_lshr_b32 s56, s56, s65
    s_lshl_b32 s56, s56, 16
    s_mov_b32 s57, s56
    s_lshl_b32 s63, s10, 12
    s_add_u32 s63, s63, 42496
    v_lshlrev_b32 v46, 4, v2
    v_add_u32 v47, s63, v46
    s_xor_b32 s63, s10, 1
    s_lshl_b32 s63, s63, 12
    s_add_u32 s63, s63, 42496
    v_add_u32 v46, s63, v46
    s_add_u32 s64, s36, 512
    v_add_u32 v198, s64, v193
    ds_read_b64 v[48:49], v45 offset:8
    ds_read_b64 v[50:51], v45 offset:0
    ds_read_b128 v[76:79], v44 offset:384
    ds_read_b128 v[92:95], v44 offset:896
    ds_read_b128 v[108:111], v44 offset:1408
    ds_read_b128 v[124:127], v44 offset:1920
    ds_read_b128 v[140:143], v44 offset:2432
    ds_read_b128 v[156:159], v44 offset:2944
    ds_read_b128 v[172:175], v44 offset:3456
    ds_read_b128 v[188:191], v44 offset:3968
    ds_read_b64 v[52:53], v45 offset:136
    ds_read_b64 v[54:55], v45 offset:128
    ds_read_b128 v[72:75], v44 offset:256
    ds_read_b128 v[88:91], v44 offset:768
    ds_read_b128 v[104:107], v44 offset:1280
    s_waitcnt lgkmcnt(14)
    ds_read_b128 v[120:123], v44 offset:1792
    s_waitcnt lgkmcnt(14)
    ds_read_b128 v[136:139], v44 offset:2304
    s_waitcnt lgkmcnt(14)
    ds_read_b128 v[152:155], v44 offset:2816
    s_waitcnt lgkmcnt(14)
    ds_read_b128 v[168:171], v44 offset:3328
    s_waitcnt lgkmcnt(14)
    ds_read_b128 v[184:187], v44 offset:3840
    s_waitcnt lgkmcnt(14)
    ds_read_b64 v[56:57], v45 offset:264
    s_waitcnt lgkmcnt(14)
    ds_read_b64 v[58:59], v45 offset:256
    s_waitcnt lgkmcnt(12)
    v_mfma_f32_16x16x32_bf16 v[8:11], v[48:51], v[76:79], 0
    ds_read_b64 v[60:61], v45 offset:392
    ds_read_b64 v[62:63], v45 offset:384
    ds_read_b128 v[68:71], v44 offset:128
    s_waitcnt lgkmcnt(14)
    ds_read_b128 v[84:87], v44 offset:640
    s_waitcnt lgkmcnt(14)
    ds_read_b128 v[100:103], v44 offset:1152
    s_waitcnt lgkmcnt(14)
    ds_read_b128 v[116:119], v44 offset:1664
    s_waitcnt lgkmcnt(14)
    ds_read_b128 v[132:135], v44 offset:2176
    s_waitcnt lgkmcnt(14)
    ds_read_b128 v[148:151], v44 offset:2688
    s_waitcnt lgkmcnt(14)
    ds_read_b128 v[164:167], v44 offset:3200
    s_waitcnt lgkmcnt(14)
    ds_read_b128 v[180:183], v44 offset:3712
    v_mfma_f32_16x16x32_bf16 v[12:15], v[48:51], v[92:95], 0
    v_mfma_f32_16x16x32_bf16 v[16:19], v[48:51], v[108:111], 0
    v_mfma_f32_16x16x32_bf16 v[20:23], v[48:51], v[124:127], 0
    v_mfma_f32_16x16x32_bf16 v[24:27], v[48:51], v[140:143], 0
    v_mfma_f32_16x16x32_bf16 v[28:31], v[48:51], v[156:159], 0
    v_mfma_f32_16x16x32_bf16 v[32:35], v[48:51], v[172:175], 0
    v_mfma_f32_16x16x32_bf16 v[36:39], v[48:51], v[188:191], 0
    s_waitcnt lgkmcnt(12)
    v_mfma_f32_16x16x32_bf16 v[8:11], v[52:55], v[72:75], v[8:11]
    ds_read_b64 v[48:49], v45 offset:520
    ds_read_b64 v[50:51], v45 offset:512
    ds_read_b128 v[64:67], v44 offset:0
    s_waitcnt lgkmcnt(14)
    ds_read_b128 v[80:83], v44 offset:512
    s_waitcnt lgkmcnt(14)
    ds_read_b128 v[96:99], v44 offset:1024
    s_waitcnt lgkmcnt(14)
    ds_read_b128 v[112:115], v44 offset:1536
    s_waitcnt lgkmcnt(14)
    ds_read_b128 v[128:131], v44 offset:2048
    s_waitcnt lgkmcnt(14)
    ds_read_b128 v[144:147], v44 offset:2560
    s_waitcnt lgkmcnt(14)
    ds_read_b128 v[160:163], v44 offset:3072
    s_waitcnt lgkmcnt(14)
    ds_read_b128 v[176:179], v44 offset:3584
    v_mfma_f32_16x16x32_bf16 v[12:15], v[52:55], v[88:91], v[12:15]
    v_mfma_f32_16x16x32_bf16 v[16:19], v[52:55], v[104:107], v[16:19]
    v_mfma_f32_16x16x32_bf16 v[20:23], v[52:55], v[120:123], v[20:23]
    v_mfma_f32_16x16x32_bf16 v[24:27], v[52:55], v[136:139], v[24:27]
    v_mfma_f32_16x16x32_bf16 v[28:31], v[52:55], v[152:155], v[28:31]
    v_mfma_f32_16x16x32_bf16 v[32:35], v[52:55], v[168:171], v[32:35]
    v_mfma_f32_16x16x32_bf16 v[36:39], v[52:55], v[184:187], v[36:39]
    s_waitcnt lgkmcnt(10)
    v_mfma_f32_16x16x32_bf16 v[8:11], v[56:59], v[68:71], v[8:11]
    ds_read_b64 v[52:53], v45 offset:648
    ds_read_b64 v[54:55], v45 offset:640
    v_mfma_f32_16x16x32_bf16 v[12:15], v[56:59], v[84:87], v[12:15]
    v_mfma_f32_16x16x32_bf16 v[16:19], v[56:59], v[100:103], v[16:19]
    v_mfma_f32_16x16x32_bf16 v[20:23], v[56:59], v[116:119], v[20:23]
    v_mfma_f32_16x16x32_bf16 v[24:27], v[56:59], v[132:135], v[24:27]
    v_mfma_f32_16x16x32_bf16 v[28:31], v[56:59], v[148:151], v[28:31]
    v_mfma_f32_16x16x32_bf16 v[32:35], v[56:59], v[164:167], v[32:35]
    v_mfma_f32_16x16x32_bf16 v[36:39], v[56:59], v[180:183], v[36:39]
    s_waitcnt lgkmcnt(2)
    v_mfma_f32_16x16x32_bf16 v[8:11], v[60:63], v[64:67], v[8:11]
    ds_read_b64 v[56:57], v45 offset:776
    ds_read_b64 v[58:59], v45 offset:768
    v_mfma_f32_16x16x32_bf16 v[12:15], v[60:63], v[80:83], v[12:15]
    v_mfma_f32_16x16x32_bf16 v[16:19], v[60:63], v[96:99], v[16:19]
    v_mfma_f32_16x16x32_bf16 v[20:23], v[60:63], v[112:115], v[20:23]
    v_mfma_f32_16x16x32_bf16 v[24:27], v[60:63], v[128:131], v[24:27]
    v_mfma_f32_16x16x32_bf16 v[28:31], v[60:63], v[144:147], v[28:31]
    v_mfma_f32_16x16x32_bf16 v[32:35], v[60:63], v[160:163], v[32:35]
    v_mfma_f32_16x16x32_bf16 v[36:39], v[60:63], v[176:179], v[36:39]
    v_mfma_f32_16x16x32_bf16 v[12:15], v[48:51], v[76:79], v[12:15]
    ds_read_b64 v[60:61], v45 offset:904
    ds_read_b64 v[62:63], v45 offset:896
    v_mfma_f32_16x16x32_bf16 v[16:19], v[48:51], v[92:95], v[16:19]
    v_mfma_f32_16x16x32_bf16 v[20:23], v[48:51], v[108:111], v[20:23]
    v_mfma_f32_16x16x32_bf16 v[24:27], v[48:51], v[124:127], v[24:27]
    v_mfma_f32_16x16x32_bf16 v[28:31], v[48:51], v[140:143], v[28:31]
    v_mfma_f32_16x16x32_bf16 v[32:35], v[48:51], v[156:159], v[32:35]
    v_mfma_f32_16x16x32_bf16 v[36:39], v[48:51], v[172:175], v[36:39]
    s_waitcnt lgkmcnt(4)
    v_mfma_f32_16x16x32_bf16 v[12:15], v[52:55], v[72:75], v[12:15]
    ds_read_b64 v[48:49], v45 offset:1032
    ds_read_b64 v[50:51], v45 offset:1024
    v_mfma_f32_16x16x32_bf16 v[16:19], v[52:55], v[88:91], v[16:19]
    v_mfma_f32_16x16x32_bf16 v[20:23], v[52:55], v[104:107], v[20:23]
    v_mfma_f32_16x16x32_bf16 v[24:27], v[52:55], v[120:123], v[24:27]
    v_mfma_f32_16x16x32_bf16 v[28:31], v[52:55], v[136:139], v[28:31]
    v_mfma_f32_16x16x32_bf16 v[32:35], v[52:55], v[152:155], v[32:35]
    v_mfma_f32_16x16x32_bf16 v[36:39], v[52:55], v[168:171], v[36:39]
    s_waitcnt lgkmcnt(4)
    v_mfma_f32_16x16x32_bf16 v[12:15], v[56:59], v[68:71], v[12:15]
    ds_read_b64 v[52:53], v45 offset:1160
    ds_read_b64 v[54:55], v45 offset:1152
    v_mfma_f32_16x16x32_bf16 v[16:19], v[56:59], v[84:87], v[16:19]
    v_mfma_f32_16x16x32_bf16 v[20:23], v[56:59], v[100:103], v[20:23]
    v_mfma_f32_16x16x32_bf16 v[24:27], v[56:59], v[116:119], v[24:27]
    v_mfma_f32_16x16x32_bf16 v[28:31], v[56:59], v[132:135], v[28:31]
    v_mfma_f32_16x16x32_bf16 v[32:35], v[56:59], v[148:151], v[32:35]
    v_mfma_f32_16x16x32_bf16 v[36:39], v[56:59], v[164:167], v[36:39]
    s_waitcnt lgkmcnt(4)
    v_mfma_f32_16x16x32_bf16 v[12:15], v[60:63], v[64:67], v[12:15]
    ds_read_b64 v[56:57], v45 offset:1288
    ds_read_b64 v[58:59], v45 offset:1280
    v_mfma_f32_16x16x32_bf16 v[16:19], v[60:63], v[80:83], v[16:19]
    v_mfma_f32_16x16x32_bf16 v[20:23], v[60:63], v[96:99], v[20:23]
    v_mfma_f32_16x16x32_bf16 v[24:27], v[60:63], v[112:115], v[24:27]
    v_mfma_f32_16x16x32_bf16 v[28:31], v[60:63], v[128:131], v[28:31]
    v_mfma_f32_16x16x32_bf16 v[32:35], v[60:63], v[144:147], v[32:35]
    v_mfma_f32_16x16x32_bf16 v[36:39], v[60:63], v[160:163], v[36:39]
    s_waitcnt lgkmcnt(4)
    v_mfma_f32_16x16x32_bf16 v[16:19], v[48:51], v[76:79], v[16:19]
    ds_read_b64 v[60:61], v45 offset:1416
    ds_read_b64 v[62:63], v45 offset:1408
    v_mfma_f32_16x16x32_bf16 v[20:23], v[48:51], v[92:95], v[20:23]
    v_mfma_f32_16x16x32_bf16 v[24:27], v[48:51], v[108:111], v[24:27]
    v_mfma_f32_16x16x32_bf16 v[28:31], v[48:51], v[124:127], v[28:31]
    v_mfma_f32_16x16x32_bf16 v[32:35], v[48:51], v[140:143], v[32:35]
    v_mfma_f32_16x16x32_bf16 v[36:39], v[48:51], v[156:159], v[36:39]
    s_waitcnt lgkmcnt(4)
    v_mfma_f32_16x16x32_bf16 v[16:19], v[52:55], v[72:75], v[16:19]
    ds_read_b64 v[48:49], v45 offset:1544
    ds_read_b64 v[50:51], v45 offset:1536
    v_mfma_f32_16x16x32_bf16 v[20:23], v[52:55], v[88:91], v[20:23]
    v_mfma_f32_16x16x32_bf16 v[24:27], v[52:55], v[104:107], v[24:27]
    v_mfma_f32_16x16x32_bf16 v[28:31], v[52:55], v[120:123], v[28:31]
    v_mfma_f32_16x16x32_bf16 v[32:35], v[52:55], v[136:139], v[32:35]
    v_mfma_f32_16x16x32_bf16 v[36:39], v[52:55], v[152:155], v[36:39]
    s_waitcnt lgkmcnt(4)
    v_mfma_f32_16x16x32_bf16 v[16:19], v[56:59], v[68:71], v[16:19]
    ds_read_b64 v[52:53], v45 offset:1672
    ds_read_b64 v[54:55], v45 offset:1664
    v_mfma_f32_16x16x32_bf16 v[20:23], v[56:59], v[84:87], v[20:23]
    v_mfma_f32_16x16x32_bf16 v[24:27], v[56:59], v[100:103], v[24:27]
    v_mfma_f32_16x16x32_bf16 v[28:31], v[56:59], v[116:119], v[28:31]
    v_mfma_f32_16x16x32_bf16 v[32:35], v[56:59], v[132:135], v[32:35]
    v_mfma_f32_16x16x32_bf16 v[36:39], v[56:59], v[148:151], v[36:39]
    s_waitcnt lgkmcnt(4)
    v_mfma_f32_16x16x32_bf16 v[16:19], v[60:63], v[64:67], v[16:19]
    ds_read_b64 v[56:57], v45 offset:1800
    ds_read_b64 v[58:59], v45 offset:1792
    v_mfma_f32_16x16x32_bf16 v[20:23], v[60:63], v[80:83], v[20:23]
    v_mfma_f32_16x16x32_bf16 v[24:27], v[60:63], v[96:99], v[24:27]
    v_mfma_f32_16x16x32_bf16 v[28:31], v[60:63], v[112:115], v[28:31]
    v_mfma_f32_16x16x32_bf16 v[32:35], v[60:63], v[128:131], v[32:35]
    v_mfma_f32_16x16x32_bf16 v[36:39], v[60:63], v[144:147], v[36:39]
    s_waitcnt lgkmcnt(4)
    v_mfma_f32_16x16x32_bf16 v[20:23], v[48:51], v[76:79], v[20:23]
    ds_read_b64 v[60:61], v45 offset:1928
    ds_read_b64 v[62:63], v45 offset:1920
    v_mfma_f32_16x16x32_bf16 v[24:27], v[48:51], v[92:95], v[24:27]
    v_mfma_f32_16x16x32_bf16 v[28:31], v[48:51], v[108:111], v[28:31]
    v_mfma_f32_16x16x32_bf16 v[32:35], v[48:51], v[124:127], v[32:35]
    v_mfma_f32_16x16x32_bf16 v[36:39], v[48:51], v[140:143], v[36:39]
    s_waitcnt lgkmcnt(4)
    v_mfma_f32_16x16x32_bf16 v[20:23], v[52:55], v[72:75], v[20:23]
    ds_read_b64 v[48:49], v45 offset:2056
    ds_read_b64 v[50:51], v45 offset:2048
    v_mfma_f32_16x16x32_bf16 v[24:27], v[52:55], v[88:91], v[24:27]
    v_mfma_f32_16x16x32_bf16 v[28:31], v[52:55], v[104:107], v[28:31]
    v_mfma_f32_16x16x32_bf16 v[32:35], v[52:55], v[120:123], v[32:35]
    v_mfma_f32_16x16x32_bf16 v[36:39], v[52:55], v[136:139], v[36:39]
    s_waitcnt lgkmcnt(4)
    v_mfma_f32_16x16x32_bf16 v[20:23], v[56:59], v[68:71], v[20:23]
    ds_read_b64 v[52:53], v45 offset:2184
    ds_read_b64 v[54:55], v45 offset:2176
    v_mfma_f32_16x16x32_bf16 v[24:27], v[56:59], v[84:87], v[24:27]
    v_mfma_f32_16x16x32_bf16 v[28:31], v[56:59], v[100:103], v[28:31]
    v_mfma_f32_16x16x32_bf16 v[32:35], v[56:59], v[116:119], v[32:35]
    v_mfma_f32_16x16x32_bf16 v[36:39], v[56:59], v[132:135], v[36:39]
    s_waitcnt lgkmcnt(4)
    v_mfma_f32_16x16x32_bf16 v[20:23], v[60:63], v[64:67], v[20:23]
    ds_read_b64 v[56:57], v45 offset:2312
    ds_read_b64 v[58:59], v45 offset:2304
    v_mfma_f32_16x16x32_bf16 v[24:27], v[60:63], v[80:83], v[24:27]
    v_mfma_f32_16x16x32_bf16 v[28:31], v[60:63], v[96:99], v[28:31]
    v_mfma_f32_16x16x32_bf16 v[32:35], v[60:63], v[112:115], v[32:35]
    v_mfma_f32_16x16x32_bf16 v[36:39], v[60:63], v[128:131], v[36:39]
    s_waitcnt lgkmcnt(4)
    v_mfma_f32_16x16x32_bf16 v[24:27], v[48:51], v[76:79], v[24:27]
    ds_read_b64 v[60:61], v45 offset:2440
    ds_read_b64 v[62:63], v45 offset:2432
    v_mfma_f32_16x16x32_bf16 v[28:31], v[48:51], v[92:95], v[28:31]
    v_mfma_f32_16x16x32_bf16 v[32:35], v[48:51], v[108:111], v[32:35]
    v_mfma_f32_16x16x32_bf16 v[36:39], v[48:51], v[124:127], v[36:39]
    s_waitcnt lgkmcnt(4)
    v_mfma_f32_16x16x32_bf16 v[24:27], v[52:55], v[72:75], v[24:27]
    ds_read_b64 v[48:49], v45 offset:2568
    ds_read_b64 v[50:51], v45 offset:2560
    v_mfma_f32_16x16x32_bf16 v[28:31], v[52:55], v[88:91], v[28:31]
    v_mfma_f32_16x16x32_bf16 v[32:35], v[52:55], v[104:107], v[32:35]
    v_mfma_f32_16x16x32_bf16 v[36:39], v[52:55], v[120:123], v[36:39]
    s_cmp_eq_u32 s12, 0
    s_cbranch_scc1 k2sw_5
    v_swap_b32 v8, v16
    v_swap_b32 v9, v17
    v_swap_b32 v10, v18
    v_swap_b32 v11, v19
    v_swap_b32 v12, v20
    v_swap_b32 v13, v21
    v_swap_b32 v14, v22
    v_swap_b32 v15, v23
k2sw_5:
    ds_write_b128 v47, v[16:19] offset:0
    ds_write_b128 v47, v[20:23] offset:1024
    ds_read_b64 v[252:253], v198 offset:0
    ds_read_b64 v[254:255], v198 offset:512
    s_waitcnt lgkmcnt(0)
    s_barrier
    ds_read_b128 v[244:247], v46 offset:0
    ds_read_b128 v[248:251], v46 offset:1024
    v_mfma_f32_16x16x32_bf16 v[24:27], v[56:59], v[68:71], v[24:27]
    ds_read_b64 v[52:53], v45 offset:2696
    ds_read_b64 v[54:55], v45 offset:2688
    v_mfma_f32_16x16x32_bf16 v[28:31], v[56:59], v[84:87], v[28:31]
    v_mfma_f32_16x16x32_bf16 v[32:35], v[56:59], v[100:103], v[32:35]
    v_mfma_f32_16x16x32_bf16 v[36:39], v[56:59], v[116:119], v[36:39]
    v_mfma_f32_16x16x32_bf16 v[24:27], v[60:63], v[64:67], v[24:27]
    ds_read_b64 v[56:57], v45 offset:2824
    ds_read_b64 v[58:59], v45 offset:2816
    v_mfma_f32_16x16x32_bf16 v[28:31], v[60:63], v[80:83], v[28:31]
    v_mfma_f32_16x16x32_bf16 v[32:35], v[60:63], v[96:99], v[32:35]
    v_mfma_f32_16x16x32_bf16 v[36:39], v[60:63], v[112:115], v[36:39]
    s_waitcnt lgkmcnt(4)
    s_waitcnt vmcnt(0)
    v_mfma_f32_16x16x32_bf16 v[28:31], v[48:51], v[76:79], v[28:31]
    ds_read_b64 v[60:61], v45 offset:2952
    ds_read_b64 v[62:63], v45 offset:2944
    v_pk_add_f32 v[8:9], v[8:9], v[244:245]
    v_pk_add_f32 v[10:11], v[10:11], v[246:247]
    v_mfma_f32_16x16x32_bf16 v[32:35], v[48:51], v[92:95], v[32:35]
    v_lshlrev_b32 v40, 16, v200
    v_and_b32 v41, 0xffff0000, v200
    v_mfma_f32_16x16x32_bf16 v[36:39], v[48:51], v[108:111], v[36:39]
    v_and_b32 v42, 0xffff0000, v253
    v_lshlrev_b32 v43, 16, v253
    s_waitcnt lgkmcnt(4)
    v_mfma_f32_16x16x32_bf16 v[28:31], v[52:55], v[72:75], v[28:31]
    ds_read_b64 v[48:49], v45 offset:3080
    ds_read_b64 v[50:51], v45 offset:3072
    v_pk_fma_f32 v[8:9], v[42:43], s[56:57], v[8:9]
    v_pk_fma_f32 v[42:43], v[40:41], v[208:209], v[224:225] neg_lo:[0,0,1] neg_hi:[0,0,1]
    v_mfma_f32_16x16x32_bf16 v[32:35], v[52:55], v[88:91], v[32:35]
    v_pk_fma_f32 v[42:43], v[42:43], v[240:241], v[240:241] op_sel:[0,1,0] op_sel_hi:[1,1,0]
    v_pk_mul_f32 v[42:43], v[42:43], v[8:9]
    v_mfma_f32_16x16x32_bf16 v[36:39], v[52:55], v[104:107], v[36:39]
    v_pk_fma_f32 v[8:9], v[42:43], v[242:243], v[40:41]
    v_lshlrev_b32 v40, 16, v201
    s_waitcnt lgkmcnt(4)
    v_mfma_f32_16x16x32_bf16 v[28:31], v[56:59], v[68:71], v[28:31]
    ds_read_b64 v[52:53], v45 offset:3208
    ds_read_b64 v[54:55], v45 offset:3200
    v_and_b32 v41, 0xffff0000, v201
    v_and_b32 v42, 0xffff0000, v252
    v_mfma_f32_16x16x32_bf16 v[32:35], v[56:59], v[84:87], v[32:35]
    v_lshlrev_b32 v43, 16, v252
    v_pk_fma_f32 v[10:11], v[42:43], s[56:57], v[10:11]
    v_mfma_f32_16x16x32_bf16 v[36:39], v[56:59], v[100:103], v[36:39]
    v_pk_fma_f32 v[42:43], v[40:41], v[210:211], v[226:227] neg_lo:[0,0,1] neg_hi:[0,0,1]
    v_pk_fma_f32 v[42:43], v[42:43], v[240:241], v[240:241] op_sel:[0,1,0] op_sel_hi:[1,1,0]
    s_waitcnt lgkmcnt(4)
    v_mfma_f32_16x16x32_bf16 v[28:31], v[60:63], v[64:67], v[28:31]
    ds_read_b64 v[56:57], v45 offset:3336
    ds_read_b64 v[58:59], v45 offset:3328
    v_pk_mul_f32 v[42:43], v[42:43], v[10:11]
    v_pk_fma_f32 v[10:11], v[42:43], v[242:243], v[40:41]
    v_mfma_f32_16x16x32_bf16 v[32:35], v[60:63], v[80:83], v[32:35]
    v_cvt_pk_bf16_f32 v16, v8, v9
    v_cvt_pk_bf16_f32 v17, v10, v11
    v_mfma_f32_16x16x32_bf16 v[36:39], v[60:63], v[96:99], v[36:39]
    buffer_store_dwordx2 v[16:17], v193, s[28:31], 0 offen offset:0 sc1
    v_pk_add_f32 v[12:13], v[12:13], v[248:249]
    s_waitcnt lgkmcnt(4)
    v_mfma_f32_16x16x32_bf16 v[32:35], v[48:51], v[76:79], v[32:35]
    ds_read_b64 v[60:61], v45 offset:3464
    ds_read_b64 v[62:63], v45 offset:3456
    v_pk_add_f32 v[14:15], v[14:15], v[250:251]
    v_lshlrev_b32 v40, 16, v202
    v_mfma_f32_16x16x32_bf16 v[36:39], v[48:51], v[92:95], v[36:39]
    v_and_b32 v41, 0xffff0000, v202
    v_and_b32 v42, 0xffff0000, v255
    s_waitcnt lgkmcnt(4)
    v_mfma_f32_16x16x32_bf16 v[32:35], v[52:55], v[72:75], v[32:35]
    ds_read_b64 v[48:49], v45 offset:3592
    ds_read_b64 v[50:51], v45 offset:3584
    v_lshlrev_b32 v43, 16, v255
    v_pk_fma_f32 v[12:13], v[42:43], s[56:57], v[12:13]
    v_mfma_f32_16x16x32_bf16 v[36:39], v[52:55], v[88:91], v[36:39]
    v_pk_fma_f32 v[42:43], v[40:41], v[212:213], v[228:229] neg_lo:[0,0,1] neg_hi:[0,0,1]
    v_pk_fma_f32 v[42:43], v[42:43], v[240:241], v[240:241] op_sel:[0,1,0] op_sel_hi:[1,1,0]
    s_waitcnt lgkmcnt(4)
    v_mfma_f32_16x16x32_bf16 v[32:35], v[56:59], v[68:71], v[32:35]
    ds_read_b64 v[52:53], v45 offset:3720
    ds_read_b64 v[54:55], v45 offset:3712
    v_pk_mul_f32 v[42:43], v[42:43], v[12:13]
    v_pk_fma_f32 v[12:13], v[42:43], v[242:243], v[40:41]
    v_mfma_f32_16x16x32_bf16 v[36:39], v[56:59], v[84:87], v[36:39]
    v_lshlrev_b32 v40, 16, v203
    v_and_b32 v41, 0xffff0000, v203
    s_waitcnt lgkmcnt(4)
    v_mfma_f32_16x16x32_bf16 v[32:35], v[60:63], v[64:67], v[32:35]
    ds_read_b64 v[56:57], v45 offset:3848
    ds_read_b64 v[58:59], v45 offset:3840
    v_and_b32 v42, 0xffff0000, v254
    v_lshlrev_b32 v43, 16, v254
    v_mfma_f32_16x16x32_bf16 v[36:39], v[60:63], v[80:83], v[36:39]
    v_pk_fma_f32 v[14:15], v[42:43], s[56:57], v[14:15]
    v_pk_fma_f32 v[42:43], v[40:41], v[214:215], v[230:231] neg_lo:[0,0,1] neg_hi:[0,0,1]
    s_waitcnt lgkmcnt(4)
    v_mfma_f32_16x16x32_bf16 v[36:39], v[48:51], v[76:79], v[36:39]
    ds_read_b64 v[60:61], v45 offset:3976
    ds_read_b64 v[62:63], v45 offset:3968
    v_pk_fma_f32 v[42:43], v[42:43], v[240:241], v[240:241] op_sel:[0,1,0] op_sel_hi:[1,1,0]
    v_pk_mul_f32 v[42:43], v[42:43], v[14:15]
    s_waitcnt lgkmcnt(4)
    v_mfma_f32_16x16x32_bf16 v[36:39], v[52:55], v[72:75], v[36:39]
    v_pk_fma_f32 v[14:15], v[42:43], v[242:243], v[40:41]
    v_cvt_pk_bf16_f32 v18, v12, v13
    s_waitcnt lgkmcnt(2)
    v_mfma_f32_16x16x32_bf16 v[36:39], v[56:59], v[68:71], v[36:39]
    v_cvt_pk_bf16_f32 v19, v14, v15
    buffer_store_dwordx2 v[18:19], v193, s[28:31], 0 offen offset:512 sc1
    s_waitcnt lgkmcnt(0)
    v_mfma_f32_16x16x32_bf16 v[36:39], v[60:63], v[64:67], v[36:39]
    s_cmp_eq_u32 s12, 0
    s_cbranch_scc1 k2sw_6
    v_swap_b32 v24, v32
    v_swap_b32 v25, v33
    v_swap_b32 v26, v34
    v_swap_b32 v27, v35
    s_nop 1
    v_swap_b32 v28, v36
    v_swap_b32 v29, v37
    v_swap_b32 v30, v38
    v_swap_b32 v31, v39
k2sw_6:
    ds_write_b128 v47, v[32:35] offset:2048
    ds_write_b128 v47, v[36:39] offset:3072
    ds_read_b64 v[252:253], v198 offset:2048
    ds_read_b64 v[254:255], v198 offset:2560
    s_waitcnt lgkmcnt(0)
    s_barrier
    ds_read_b128 v[244:247], v46 offset:2048
    ds_read_b128 v[248:251], v46 offset:3072
    s_waitcnt lgkmcnt(0)
    v_pk_add_f32 v[24:25], v[24:25], v[244:245]
    v_pk_add_f32 v[26:27], v[26:27], v[246:247]
    v_lshlrev_b32 v40, 16, v204
    v_and_b32 v41, 0xffff0000, v204
    v_and_b32 v42, 0xffff0000, v253
    v_lshlrev_b32 v43, 16, v253
    v_pk_fma_f32 v[24:25], v[42:43], s[56:57], v[24:25]
    v_pk_fma_f32 v[42:43], v[40:41], v[216:217], v[232:233] neg_lo:[0,0,1] neg_hi:[0,0,1]
    v_pk_fma_f32 v[42:43], v[42:43], v[240:241], v[240:241] op_sel:[0,1,0] op_sel_hi:[1,1,0]
    v_pk_mul_f32 v[42:43], v[42:43], v[24:25]
    v_pk_fma_f32 v[24:25], v[42:43], v[242:243], v[40:41]
    v_lshlrev_b32 v40, 16, v205
    v_and_b32 v41, 0xffff0000, v205
    v_and_b32 v42, 0xffff0000, v252
    v_lshlrev_b32 v43, 16, v252
    v_pk_fma_f32 v[26:27], v[42:43], s[56:57], v[26:27]
    v_pk_fma_f32 v[42:43], v[40:41], v[218:219], v[234:235] neg_lo:[0,0,1] neg_hi:[0,0,1]
    v_pk_fma_f32 v[42:43], v[42:43], v[240:241], v[240:241] op_sel:[0,1,0] op_sel_hi:[1,1,0]
    v_pk_mul_f32 v[42:43], v[42:43], v[26:27]
    v_pk_fma_f32 v[26:27], v[42:43], v[242:243], v[40:41]
    v_cvt_pk_bf16_f32 v32, v24, v25
    v_cvt_pk_bf16_f32 v33, v26, v27
    buffer_store_dwordx2 v[32:33], v193, s[28:31], 0 offen offset:2048 sc1
    v_pk_add_f32 v[28:29], v[28:29], v[248:249]
    v_pk_add_f32 v[30:31], v[30:31], v[250:251]
    v_lshlrev_b32 v40, 16, v206
    v_and_b32 v41, 0xffff0000, v206
    v_and_b32 v42, 0xffff0000, v255
    v_lshlrev_b32 v43, 16, v255
    v_pk_fma_f32 v[28:29], v[42:43], s[56:57], v[28:29]
    v_pk_fma_f32 v[42:43], v[40:41], v[220:221], v[236:237] neg_lo:[0,0,1] neg_hi:[0,0,1]
    v_pk_fma_f32 v[42:43], v[42:43], v[240:241], v[240:241] op_sel:[0,1,0] op_sel_hi:[1,1,0]
    v_pk_mul_f32 v[42:43], v[42:43], v[28:29]
    v_pk_fma_f32 v[28:29], v[42:43], v[242:243], v[40:41]
    v_lshlrev_b32 v40, 16, v207
    v_and_b32 v41, 0xffff0000, v207
    v_and_b32 v42, 0xffff0000, v254
    v_lshlrev_b32 v43, 16, v254
    v_pk_fma_f32 v[30:31], v[42:43], s[56:57], v[30:31]
    v_pk_fma_f32 v[42:43], v[40:41], v[222:223], v[238:239] neg_lo:[0,0,1] neg_hi:[0,0,1]
    v_pk_fma_f32 v[42:43], v[42:43], v[240:241], v[240:241] op_sel:[0,1,0] op_sel_hi:[1,1,0]
    v_pk_mul_f32 v[42:43], v[42:43], v[30:31]
    v_pk_fma_f32 v[30:31], v[42:43], v[242:243], v[40:41]
    v_cvt_pk_bf16_f32 v34, v28, v29
    v_cvt_pk_bf16_f32 v35, v30, v31
    buffer_store_dwordx2 v[34:35], v193, s[28:31], 0 offen offset:2560 sc1
    s_endpgm
k2_side:
    s_sub_u32 s63, s2, 256
    s_waitcnt lgkmcnt(0)
    s_load_dwordx4 s[4:7], s[0:1], 56
    s_load_dwordx2 s[8:9], s[0:1], 104
    v_lshrrev_b32 v1, 6, v0
    v_and_b32 v2, 63, v0
    v_readfirstlane_b32 s10, v1
    s_and_b32 s11, s63, 15
    s_lshr_b32 s12, s63, 4
    s_lshl_b32 s13, s11, 5
    s_nop 0
    s_lshl_b32 s14, s10, 3
    s_add_u32 s13, s13, s14
    s_waitcnt lgkmcnt(0)
    s_mov_b32 s16, s4
    s_mov_b32 s17, s5
    s_mov_b32 s18, 1835008
    s_mov_b32 s19, 0x20000
    s_mov_b32 s20, s6
    s_mov_b32 s21, s7
    s_mov_b32 s22, 1835008
    s_mov_b32 s23, 0x20000
    s_add_u32 s64, s8, 6307840
    s_addc_u32 s65, s9, 0
    s_mov_b32 s66, 49152
    s_mov_b32 s67, 0x20000
    v_lshrrev_b32 v60, 3, v2
    v_and_b32 v61, 7, v2
    v_lshlrev_b32 v60, 11, v60
    v_lshl_add_u32 v60, v61, 2, v60
    s_lshl_b32 s14, s13, 2
    s_add_u32 s14, s14, 6144
    buffer_load_dword v61, v60, s[64:67], s14 offen
    s_add_u32 s14, s14, 12288
    buffer_load_dword v62, v60, s[64:67], s14 offen
    s_add_u32 s14, s14, 12288
    buffer_load_dword v63, v60, s[64:67], s14 offen
    s_add_u32 s14, s14, 12288
    buffer_load_dword v64, v60, s[64:67], s14 offen
    s_and_b32 s14, s63, 1
    s_lshl_b32 s14, s14, 10
    s_add_u32 s14, s14, 10240
    v_lshlrev_b32 v65, 2, v0
    buffer_load_dword v66, v65, s[64:67], s14 offen
    s_add_u32 s15, s14, 12288
    buffer_load_dword v67, v65, s[64:67], s15 offen
    s_add_u32 s15, s15, 12288
    buffer_load_dword v68, v65, s[64:67], s15 offen
    s_add_u32 s15, s15, 12288
    buffer_load_dword v69, v65, s[64:67], s15 offen
    s_mov_b32 s68, s14
    s_lshl_b32 s14, s12, 8
    v_lshlrev_b32 v3, 2, v2
    v_add_u32 v3, s14, v3
    s_mul_i32 s14, s13, 3584
    buffer_load_dword v8, v3, s[16:19], s14 offen
    s_add_u32 s14, s14, 3584
    buffer_load_dword v9, v3, s[16:19], s14 offen
    s_add_u32 s14, s14, 3584
    buffer_load_dword v10, v3, s[16:19], s14 offen
    s_add_u32 s14, s14, 3584
    buffer_load_dword v11, v3, s[16:19], s14 offen
    s_add_u32 s14, s14, 3584
    buffer_load_dword v12, v3, s[16:19], s14 offen
    s_add_u32 s14, s14, 3584
    buffer_load_dword v13, v3, s[16:19], s14 offen
    s_add_u32 s14, s14, 3584
    buffer_load_dword v14, v3, s[16:19], s14 offen
    s_add_u32 s14, s14, 3584
    buffer_load_dword v15, v3, s[16:19], s14 offen
    s_lshr_b32 s26, s63, 2
    s_lshr_b32 s27, s63, 1
    s_and_b32 s27, s27, 1
    s_and_b32 s28, s63, 1
    s_lshl_b32 s29, s26, 5
    s_lshl_b32 s30, s27, 4
    s_add_u32 s29, s29, s30
    s_lshl_b32 s30, s28, 2
    s_add_u32 s29, s29, s30
    s_lshl_b32 s29, s29, 10
    v_lshlrev_b32 v4, 2, v0
    s_add_u32 s30, s29, 0
    buffer_load_dword v16, v4, s[20:23], s30 offen
    s_add_u32 s30, s29, 1024
    buffer_load_dword v17, v4, s[20:23], s30 offen
    s_add_u32 s30, s29, 2048
    buffer_load_dword v18, v4, s[20:23], s30 offen
    s_add_u32 s30, s29, 3072
    buffer_load_dword v19, v4, s[20:23], s30 offen
    s_add_u32 s30, s29, 8192
    buffer_load_dword v20, v4, s[20:23], s30 offen
    s_add_u32 s30, s29, 9216
    buffer_load_dword v21, v4, s[20:23], s30 offen
    s_add_u32 s30, s29, 10240
    buffer_load_dword v22, v4, s[20:23], s30 offen
    s_add_u32 s30, s29, 11264
    buffer_load_dword v23, v4, s[20:23], s30 offen
    s_add_u32 s48, s8, 7340032
    s_addc_u32 s49, s9, 0
    s_mov_b32 s50, 1835008
    s_mov_b32 s51, 0x20000
    s_add_u32 s52, s8, 9437184
    s_addc_u32 s53, s9, 0
    s_mov_b32 s54, 1835008
    s_mov_b32 s55, 0x20000
    s_add_u32 s56, s8, 6422528
    s_addc_u32 s57, s9, 0
    s_mov_b32 s58, 229376
    s_mov_b32 s59, 0x20000
    s_mov_b32 s60, 0x05040100
    s_mov_b32 s61, 0x07060302
    s_mov_b32 s62, 0x3f803f80
    s_waitcnt vmcnt(16)
    v_add_f32 v61, v61, v62
    v_add_f32 v63, v63, v64
    v_add_f32 v66, v66, v67
    v_add_f32 v68, v68, v69
    v_add_f32 v61, v61, v63
    v_add_f32 v66, v66, v68
    v_cvt_pk_bf16_f32 v61, v61, v66
    v_and_b32 v66, 0xffff0000, v61
    v_lshlrev_b32 v61, 16, v61
    v_add_f32 v62, 1.0, v61
    v_cvt_pk_bf16_f32 v62, v62, v62
    v_lshlrev_b32 v62, 16, v62
    v_readlane_b32 s32, v61, 0
    v_readlane_b32 s40, v62, 8
    v_readlane_b32 s33, v61, 1
    v_readlane_b32 s41, v62, 9
    v_readlane_b32 s34, v61, 2
    v_readlane_b32 s42, v62, 10
    v_readlane_b32 s35, v61, 3
    v_readlane_b32 s43, v62, 11
    v_readlane_b32 s36, v61, 4
    v_readlane_b32 s44, v62, 12
    v_readlane_b32 s37, v61, 5
    v_readlane_b32 s45, v62, 13
    v_readlane_b32 s38, v61, 6
    v_readlane_b32 s46, v62, 14
    v_readlane_b32 s39, v61, 7
    v_readlane_b32 s47, v62, 15
    s_add_u32 s64, s8, 6356992
    s_addc_u32 s65, s9, 0
    s_mov_b32 s66, 12288
    s_mov_b32 s67, 0x20000
    s_cmp_ge_u32 s63, 2
    s_cbranch_scc1 side_nogb
    buffer_store_dword v66, v65, s[64:67], s68 offen sc1
side_nogb:
    s_waitcnt vmcnt(8)
    v_lshlrev_b32 v24, 16, v8
    v_and_b32 v32, 0xffff0000, v8
    v_lshlrev_b32 v25, 16, v9
    v_and_b32 v33, 0xffff0000, v9
    v_lshlrev_b32 v26, 16, v10
    v_and_b32 v34, 0xffff0000, v10
    v_lshlrev_b32 v27, 16, v11
    v_and_b32 v35, 0xffff0000, v11
    v_lshlrev_b32 v28, 16, v12
    v_and_b32 v36, 0xffff0000, v12
    v_lshlrev_b32 v29, 16, v13
    v_and_b32 v37, 0xffff0000, v13
    v_lshlrev_b32 v30, 16, v14
    v_and_b32 v38, 0xffff0000, v14
    v_lshlrev_b32 v31, 16, v15
    v_and_b32 v39, 0xffff0000, v15
    v_mul_f32 v42, s32, v24
    v_mul_f32 v43, s32, v32
    v_fmac_f32 v42, s33, v25
    v_fmac_f32 v43, s33, v33
    v_fmac_f32 v42, s34, v26
    v_fmac_f32 v43, s34, v34
    v_fmac_f32 v42, s35, v27
    v_fmac_f32 v43, s35, v35
    v_fmac_f32 v42, s36, v28
    v_fmac_f32 v43, s36, v36
    v_fmac_f32 v42, s37, v29
    v_fmac_f32 v43, s37, v37
    v_fmac_f32 v42, s38, v30
    v_fmac_f32 v43, s38, v38
    v_fmac_f32 v42, s39, v31
    v_fmac_f32 v43, s39, v39
    v_mul_f32 v24, s40, v24
    v_mul_f32 v32, s40, v32
    v_mul_f32 v25, s41, v25
    v_mul_f32 v33, s41, v33
    v_mul_f32 v26, s42, v26
    v_mul_f32 v34, s42, v34
    v_mul_f32 v27, s43, v27
    v_mul_f32 v35, s43, v35
    v_mul_f32 v28, s44, v28
    v_mul_f32 v36, s44, v36
    v_mul_f32 v29, s45, v29
    v_mul_f32 v37, s45, v37
    v_mul_f32 v30, s46, v30
    v_mul_f32 v38, s46, v38
    v_mul_f32 v31, s47, v31
    v_mul_f32 v39, s47, v39
    v_cvt_pk_bf16_f32 v44, v24, v25
    v_cvt_pk_bf16_f32 v48, v32, v33
    v_cvt_pk_bf16_f32 v45, v26, v27
    v_cvt_pk_bf16_f32 v49, v34, v35
    v_cvt_pk_bf16_f32 v46, v28, v29
    v_cvt_pk_bf16_f32 v50, v36, v37
    v_cvt_pk_bf16_f32 v47, v30, v31
    v_cvt_pk_bf16_f32 v51, v38, v39
    v_mov_b32 v40, 0
    v_mov_b32 v41, 0
    v_dot2c_f32_bf16 v40, s62, v44
    v_dot2c_f32_bf16 v41, s62, v48
    v_dot2c_f32_bf16 v40, s62, v45
    v_dot2c_f32_bf16 v41, s62, v49
    v_dot2c_f32_bf16 v40, s62, v46
    v_dot2c_f32_bf16 v41, s62, v50
    v_dot2c_f32_bf16 v40, s62, v47
    v_dot2c_f32_bf16 v41, s62, v51
    v_lshrrev_b32 v5, 4, v2
    v_lshlrev_b32 v5, 11, v5
    v_and_b32 v6, 15, v2
    v_lshl_add_u32 v5, v6, 5, v5
    s_lshr_b32 s15, s10, 1
    s_lshl_b32 s15, s15, 10
    s_and_b32 s14, s10, 1
    s_lshl_b32 s14, s14, 9
    s_add_u32 s14, s14, s15
    s_add_u32 s14, s14, 4096
    v_add_u32 v5, s14, v5
    ds_write_b128 v5, v[44:47]
    ds_write_b128 v5, v[48:51] offset:16
    v_lshlrev_b32 v6, 4, v2
    s_lshl_b32 s15, s10, 10
    v_add_u32 v6, s15, v6
    ds_write_b128 v6, v[40:43]
    s_waitcnt vmcnt(0)
    v_perm_b32 v52, v17, v16, s60
    v_perm_b32 v53, v19, v18, s60
    v_perm_b32 v54, v21, v20, s60
    v_perm_b32 v55, v23, v22, s60
    v_perm_b32 v56, v17, v16, s61
    v_perm_b32 v57, v19, v18, s61
    v_perm_b32 v58, v21, v20, s61
    v_perm_b32 v59, v23, v22, s61
    v_lshrrev_b32 v5, 4, v0
    v_lshlrev_b32 v5, 9, v5
    v_and_b32 v6, 15, v0
    v_lshl_add_u32 v5, v6, 5, v5
    ds_write_b128 v5, v[52:55] offset:12288
    ds_write_b128 v5, v[56:59] offset:12304
    s_waitcnt lgkmcnt(0)
    s_barrier
    s_lshl_b32 s15, s10, 11
    v_lshlrev_b32 v6, 4, v2
    v_add_u32 v5, s15, v6
    ds_read_b128 v[24:27], v5 offset:4096
    ds_read_b128 v[28:31], v5 offset:5120
    v_lshlrev_b32 v7, 4, v0
    ds_read_b128 v[32:35], v7 offset:12288
    ds_read_b128 v[36:39], v7 offset:16384
    s_lshl_b32 s14, s12, 17
    s_lshl_b32 s15, s10, 15
    s_add_u32 s14, s14, s15
    s_lshl_b32 s15, s11, 11
    s_add_u32 s14, s14, s15
    v_lshrrev_b32 v8, 6, v0
    s_mov_b32 s15, 229376
    v_mul_lo_u32 v8, v8, s15
    v_lshrrev_b32 v9, 5, v0
    v_and_b32 v9, 1, v9
    v_lshl_add_u32 v8, v9, 10, v8
    v_and_b32 v9, 31, v0
    v_lshl_add_u32 v8, v9, 4, v8
    s_lshl_b32 s69, s26, 12
    s_lshl_b32 s15, s27, 11
    s_add_u32 s69, s69, s15
    s_lshl_b32 s15, s28, 9
    s_add_u32 s69, s69, s15
    s_add_u32 s70, s69, 917504
    s_waitcnt lgkmcnt(0)
    buffer_store_dwordx4 v[24:27], v6, s[48:51], s14 offen sc1
    buffer_store_dwordx4 v[28:31], v6, s[48:51], s14 offen offset:1024 sc1
    buffer_store_dwordx4 v[32:35], v8, s[52:55], s69 offen sc1
    buffer_store_dwordx4 v[36:39], v8, s[52:55], s70 offen sc1
    s_waitcnt lgkmcnt(0)
    s_barrier
    v_and_b32 v6, 127, v0
    v_lshrrev_b32 v7, 7, v0
    v_lshrrev_b32 v5, 1, v6
    v_lshlrev_b32 v5, 4, v5
    v_lshl_add_u32 v5, v7, 3, v5
    v_and_b32 v8, 1, v0
    v_lshl_add_u32 v5, v8, 2, v5
    ds_read_b32 v8, v5
    ds_read_b32 v9, v5 offset:1024
    ds_read_b32 v10, v5 offset:2048
    ds_read_b32 v11, v5 offset:3072
    v_mul_u32_u24 v7, 7168, v7
    v_lshl_add_u32 v7, v6, 2, v7
    s_mul_i32 s14, s11, 14336
    s_lshl_b32 s15, s12, 9
    s_add_u32 s14, s14, s15
    s_waitcnt lgkmcnt(0)
    v_add_f32 v8, v8, v9
    v_add_f32 v10, v10, v11
    v_add_f32 v8, v8, v10
    s_lshl_b32 s14, s12, 9
    buffer_atomic_add_f32 v8, v7, s[56:59], s14 offen
    s_endpgm
k2_done:
    s_endpgm
.globl k34_ffn_kernel
.p2align 8
.type k34_ffn_kernel,@function
k34_ffn_kernel:
    s_load_dwordx2 s[8:9], s[0:1], 104
    s_load_dwordx2 s[4:5], s[0:1], 88
    s_getpc_b64 s[24:25]
cp_7:
    s_add_u32 s24, s24, k34_top_end-cp_7
    s_addc_u32 s25, s25, 0
    s_mov_b32 s26, k34_done-k34_top_end
    s_mov_b32 s27, 0x20000
    v_mbcnt_lo_u32_b32 v250, -1, 0
    v_mbcnt_hi_u32_b32 v250, -1, v250
    v_lshlrev_b32 v250, 7, v250
    buffer_load_dword v251, v250, s[24:27], 0 offen
    v_add_u32 v250, 0x2000, v250
    buffer_load_dword v251, v250, s[24:27], 0 offen
k34_top_end:
    s_cmp_ge_u32 s2, 256
    s_cbranch_scc1 k34_done
    v_lshrrev_b32 v1, 6, v0
    v_and_b32 v2, 63, v0
    v_readfirstlane_b32 s10, v1
    s_and_b32 s11, s2, 7
    s_lshr_b32 s12, s2, 3
    s_lshr_b32 s6, s11, 1
    s_lshl_b32 s13, s6, 2
    s_and_b32 s14, s12, 3
    s_add_u32 s13, s13, s14
    s_and_b32 s14, s11, 1
    s_mul_i32 s14, s14, 7
    s_lshr_b32 s15, s12, 2
    s_add_u32 s14, s14, s15
    s_lshl_b32 s15, s14, 2
    s_add_u32 s15, s15, s10
    v_lshlrev_b32 v7, 4, v2
    v_lshrrev_b32 v5, 3, v2
    v_and_b32 v6, 7, v2
    v_lshrrev_b32 v3, 4, v2
    v_and_b32 v3, 1, v3
    v_lshlrev_b32 v3, 2, v3
    v_xor_b32 v6, v6, v3
    v_lshlrev_b32 v6, 4, v6
    v_lshl_add_u32 v6, v5, 12, v6
    s_lshl_b32 s3, s13, 8
    v_add_u32 v6, s3, v6
    s_lshl_b32 s32, s10, 16
    s_lshl_b32 s33, s10, 11
    s_lshl_b32 s3, s15, 15
    s_waitcnt lgkmcnt(0)
    s_add_u32 s16, s8, 4194304
    s_addc_u32 s17, s9, 0
    s_mov_b32 s18, 2097152
    s_mov_b32 s19, 0x20000
    s_cmp_ge_u32 s12, 28
    s_cbranch_scc1 k34_stats
    s_add_u32 s20, s8, 7340032
    s_addc_u32 s21, s9, 0
    s_add_u32 s20, s20, s3
    s_addc_u32 s21, s21, 0
    s_mov_b32 s22, 32768
    s_mov_b32 s23, 0x20000
    s_add_u32 s34, s32, 0
    s_add_u32 m0, s33, 0
    s_nop 0
    buffer_load_dwordx4 v6, s[16:19], s34 offen lds
    s_mov_b32 s35, 0
    buffer_load_dwordx4 v[64:67], v7, s[20:23], s35 offen offset:0
    s_mov_b32 s35, 0
    buffer_load_dwordx4 v[68:71], v7, s[20:23], s35 offen offset:1024
    s_add_u32 s34, s32, 32768
    s_add_u32 m0, s33, 1024
    s_nop 0
    buffer_load_dwordx4 v6, s[16:19], s34 offen lds
    s_mov_b32 s35, 0
    buffer_load_dwordx4 v[72:75], v7, s[20:23], s35 offen offset:2048
    s_mov_b32 s35, 0
    buffer_load_dwordx4 v[76:79], v7, s[20:23], s35 offen offset:3072
    s_add_u32 s34, s32, 262144
    s_add_u32 m0, s33, 8192
    s_nop 0
    buffer_load_dwordx4 v6, s[16:19], s34 offen lds
    s_mov_b32 s35, 4096
    buffer_load_dwordx4 v[80:83], v7, s[20:23], s35 offen offset:0
    s_mov_b32 s35, 4096
    buffer_load_dwordx4 v[84:87], v7, s[20:23], s35 offen offset:1024
    s_add_u32 s34, s32, 294912
    s_add_u32 m0, s33, 9216
    s_nop 0
    buffer_load_dwordx4 v6, s[16:19], s34 offen lds
    s_mov_b32 s35, 4096
    buffer_load_dwordx4 v[88:91], v7, s[20:23], s35 offen offset:2048
    s_mov_b32 s35, 4096
    buffer_load_dwordx4 v[92:95], v7, s[20:23], s35 offen offset:3072
    s_lshl_b32 s44, s6, 3
    s_and_b32 s45, s11, 1
    s_lshl_b32 s45, s45, 2
    s_add_u32 s44, s44, s45
    s_and_b32 s45, s12, 3
    s_add_u32 s44, s44, s45
    s_lshr_b32 s45, s12, 2
    s_mul_i32 s3, s45, 229376
    s_mul_i32 s7, s10, 57344
    s_add_u32 s3, s3, s7
    s_and_b32 s7, s11, 0
    s_cmp_eq_u32 s7, 0
    s_cbranch_scc1 k34_rep0_8
    s_sub_u32 s7, s7, 1
    s_lshl_b32 s7, s7, 21
    s_add_u32 s3, s3, s7
    s_add_u32 s3, s3, 11534336
k34_rep0_8:
    s_add_u32 s48, s8, 9437184
    s_addc_u32 s49, s9, 0
    s_add_u32 s48, s48, s3
    s_addc_u32 s49, s49, 0
    s_mov_b32 s50, 57344
    s_mov_b32 s51, 0x20000
    s_add_u32 s52, s8, 6815744
    s_addc_u32 s53, s9, 0
    s_mov_b32 s54, 65536
    s_mov_b32 s55, 0x20000
    s_add_u32 s56, s8, 6946816
    s_addc_u32 s57, s9, 0
    s_mov_b32 s58, 16384
    s_mov_b32 s59, 0x20000
    s_mul_i32 s3, s10, 14
    s_lshr_b32 s3, s3, 2
    s_lshr_b32 s7, s44, 1
    s_mul_i32 s7, s7, 14
    s_add_u32 s3, s3, s7
    s_lshl_b32 s47, s3, 7
    v_and_b32 v53, 3, v2
    v_lshlrev_b32 v53, 7, v53
    s_lshr_b32 s3, s44, 1
    s_lshl_b32 s3, s3, 2
    s_and_b32 s7, s44, 1
    s_add_u32 s46, s3, s7
    s_mul_i32 s3, s46, 114688
    s_mul_i32 s7, s10, 28672
    s_add_u32 s3, s3, s7
    s_add_u32 s40, s8, 11534336
    s_addc_u32 s41, s9, 0
    s_add_u32 s40, s40, s3
    s_addc_u32 s41, s41, 0
    s_mov_b32 s42, 258048
    s_mov_b32 s43, 0x20000
    s_add_u32 s24, s8, 6422528
    s_addc_u32 s25, s9, 0
    s_mov_b32 s26, 14336
    s_mov_b32 s27, 0x20000
    v_lshrrev_b32 v3, 5, v2
    v_mul_u32_u24 v3, 7168, v3
    v_and_b32 v4, 31, v2
    v_lshl_add_u32 v3, v4, 4, v3
    s_lshl_b32 s3, s14, 9
    s_mov_b32 m0, 131072
    s_nop 0
    buffer_load_dwordx4 v3, s[24:27], s3 offen lds
    s_add_u32 s34, s32, 524288
    s_add_u32 m0, s33, 16384
    s_nop 0
    buffer_load_dwordx4 v6, s[16:19], s34 offen lds
    s_mov_b32 s35, 8192
    buffer_load_dwordx4 v[96:99], v7, s[20:23], s35 offen offset:0
    s_mov_b32 s35, 8192
    buffer_load_dwordx4 v[100:103], v7, s[20:23], s35 offen offset:1024
    s_add_u32 s34, s32, 557056
    s_add_u32 m0, s33, 17408
    s_nop 0
    buffer_load_dwordx4 v6, s[16:19], s34 offen lds
    s_mov_b32 s35, 8192
    buffer_load_dwordx4 v[104:107], v7, s[20:23], s35 offen offset:2048
    s_mov_b32 s35, 8192
    buffer_load_dwordx4 v[108:111], v7, s[20:23], s35 offen offset:3072
    s_add_u32 s34, s32, 786432
    s_add_u32 m0, s33, 24576
    s_nop 0
    buffer_load_dwordx4 v6, s[16:19], s34 offen lds
    s_mov_b32 s35, 12288
    buffer_load_dwordx4 v[112:115], v7, s[20:23], s35 offen offset:0
    s_mov_b32 s35, 12288
    buffer_load_dwordx4 v[116:119], v7, s[20:23], s35 offen offset:1024
    s_add_u32 s34, s32, 819200
    s_add_u32 m0, s33, 25600
    s_nop 0
    buffer_load_dwordx4 v6, s[16:19], s34 offen lds
    s_mov_b32 s35, 12288
    buffer_load_dwordx4 v[120:123], v7, s[20:23], s35 offen offset:2048
    s_mov_b32 s35, 12288
    buffer_load_dwordx4 v[124:127], v7, s[20:23], s35 offen offset:3072
    s_add_u32 s28, s8, 11534336
    s_addc_u32 s29, s9, 0
    s_mov_b32 s30, 7340032
    s_mov_b32 s31, 0x20000
    v_lshrrev_b32 v12, 4, v2
    v_lshrrev_b32 v13, 2, v2
    v_and_b32 v13, 3, v13
    v_and_b32 v14, 3, v2
    v_lshrrev_b32 v15, 1, v12
    v_lshl_add_u32 v15, v15, 3, v13
    v_lshlrev_b32 v15, 7, v15
    v_and_b32 v16, 1, v12
    v_lshlrev_b32 v16, 1, v16
    v_lshrrev_b32 v17, 1, v14
    v_add_u32 v16, v16, v17
    v_lshl_add_u32 v15, v16, 4, v15
    v_and_b32 v17, 1, v14
    v_lshl_add_u32 v15, v17, 3, v15
    v_lshrrev_b32 v13, 1, v13
    v_lshl_add_u32 v8, v13, 6, v15
    v_xor_b32 v17, 1, v13
    v_lshl_add_u32 v9, v17, 6, v15
    v_add_u32 v10, 0x10000, v8
    v_add_u32 v11, 0x10000, v9
    v_and_b32 v52, 31, v2
    v_lshlrev_b32 v52, 3, v52
    s_lshl_b32 s62, s13, 10
    s_waitcnt vmcnt(19)
    s_barrier
    ds_read_b64_tr_b16 v[16:17], v8 offset:0
    ds_read_b64_tr_b16 v[18:19], v8 offset:512
    ds_read_b64_tr_b16 v[20:21], v9 offset:0
    ds_read_b64_tr_b16 v[22:23], v9 offset:512
    ds_read_b64_tr_b16 v[24:25], v8 offset:2048
    ds_read_b64_tr_b16 v[26:27], v8 offset:2560
    ds_read_b64_tr_b16 v[28:29], v9 offset:2048
    ds_read_b64_tr_b16 v[30:31], v9 offset:2560
    s_waitcnt lgkmcnt(6)
    v_mfma_f32_32x32x16_bf16 v[192:207], v[64:67], v[16:19], 0
    ds_read_b64_tr_b16 v[32:33], v8 offset:4096
    ds_read_b64_tr_b16 v[34:35], v8 offset:4608
    s_add_u32 s34, s32, 1048576
    s_add_u32 m0, s33, 32768
    s_nop 0
    buffer_load_dwordx4 v6, s[16:19], s34 offen lds
    s_waitcnt lgkmcnt(6)
    v_mfma_f32_32x32x16_bf16 v[208:223], v[64:67], v[20:23], 0
    ds_read_b64_tr_b16 v[36:37], v9 offset:4096
    ds_read_b64_tr_b16 v[38:39], v9 offset:4608
    s_mov_b32 s35, 16384
    buffer_load_dwordx4 v[128:131], v7, s[20:23], s35 offen offset:0
    s_waitcnt lgkmcnt(6)
    v_mfma_f32_32x32x16_bf16 v[192:207], v[68:71], v[24:27], v[192:207]
    ds_read_b64_tr_b16 v[40:41], v8 offset:6144
    ds_read_b64_tr_b16 v[42:43], v8 offset:6656
    s_mov_b32 s35, 16384
    buffer_load_dwordx4 v[132:135], v7, s[20:23], s35 offen offset:1024
    s_waitcnt lgkmcnt(6)
    v_mfma_f32_32x32x16_bf16 v[208:223], v[68:71], v[28:31], v[208:223]
    ds_read_b64_tr_b16 v[44:45], v9 offset:6144
    ds_read_b64_tr_b16 v[46:47], v9 offset:6656
    s_waitcnt vmcnt(16)
    s_barrier
    s_waitcnt lgkmcnt(6)
    v_mfma_f32_32x32x16_bf16 v[192:207], v[72:75], v[32:35], v[192:207]
    ds_read_b64_tr_b16 v[16:17], v8 offset:8192
    ds_read_b64_tr_b16 v[18:19], v8 offset:8704
    s_add_u32 s34, s32, 1081344
    s_add_u32 m0, s33, 33792
    s_nop 0
    buffer_load_dwordx4 v6, s[16:19], s34 offen lds
    s_waitcnt lgkmcnt(6)
    v_mfma_f32_32x32x16_bf16 v[208:223], v[72:75], v[36:39], v[208:223]
    ds_read_b64_tr_b16 v[20:21], v9 offset:8192
    ds_read_b64_tr_b16 v[22:23], v9 offset:8704
    s_mov_b32 s35, 16384
    buffer_load_dwordx4 v[136:139], v7, s[20:23], s35 offen offset:2048
    s_waitcnt lgkmcnt(6)
    v_mfma_f32_32x32x16_bf16 v[192:207], v[76:79], v[40:43], v[192:207]
    ds_read_b64_tr_b16 v[24:25], v8 offset:10240
    ds_read_b64_tr_b16 v[26:27], v8 offset:10752
    s_mov_b32 s35, 16384
    buffer_load_dwordx4 v[140:143], v7, s[20:23], s35 offen offset:3072
    s_waitcnt lgkmcnt(6)
    v_mfma_f32_32x32x16_bf16 v[208:223], v[76:79], v[44:47], v[208:223]
    ds_read_b64_tr_b16 v[28:29], v9 offset:10240
    ds_read_b64_tr_b16 v[30:31], v9 offset:10752
    s_waitcnt lgkmcnt(6)
    v_mfma_f32_32x32x16_bf16 v[192:207], v[80:83], v[16:19], v[192:207]
    ds_read_b64_tr_b16 v[32:33], v8 offset:12288
    ds_read_b64_tr_b16 v[34:35], v8 offset:12800
    s_add_u32 s34, s32, 1310720
    s_add_u32 m0, s33, 40960
    s_nop 0
    buffer_load_dwordx4 v6, s[16:19], s34 offen lds
    s_waitcnt lgkmcnt(6)
    v_mfma_f32_32x32x16_bf16 v[208:223], v[80:83], v[20:23], v[208:223]
    ds_read_b64_tr_b16 v[36:37], v9 offset:12288
    ds_read_b64_tr_b16 v[38:39], v9 offset:12800
    s_mov_b32 s35, 20480
    buffer_load_dwordx4 v[144:147], v7, s[20:23], s35 offen offset:0
    s_waitcnt lgkmcnt(6)
    v_mfma_f32_32x32x16_bf16 v[192:207], v[84:87], v[24:27], v[192:207]
    ds_read_b64_tr_b16 v[40:41], v8 offset:14336
    ds_read_b64_tr_b16 v[42:43], v8 offset:14848
    s_mov_b32 s35, 20480
    buffer_load_dwordx4 v[148:151], v7, s[20:23], s35 offen offset:1024
    s_waitcnt lgkmcnt(6)
    v_mfma_f32_32x32x16_bf16 v[208:223], v[84:87], v[28:31], v[208:223]
    ds_read_b64_tr_b16 v[44:45], v9 offset:14336
    ds_read_b64_tr_b16 v[46:47], v9 offset:14848
    s_waitcnt vmcnt(15)
    s_barrier
    s_waitcnt lgkmcnt(6)
    v_mfma_f32_32x32x16_bf16 v[192:207], v[88:91], v[32:35], v[192:207]
    ds_read_b64_tr_b16 v[16:17], v8 offset:16384
    ds_read_b64_tr_b16 v[18:19], v8 offset:16896
    s_add_u32 s34, s32, 1343488
    s_add_u32 m0, s33, 41984
    s_nop 0
    buffer_load_dwordx4 v6, s[16:19], s34 offen lds
    s_waitcnt lgkmcnt(6)
    v_mfma_f32_32x32x16_bf16 v[208:223], v[88:91], v[36:39], v[208:223]
    ds_read_b64_tr_b16 v[20:21], v9 offset:16384
    ds_read_b64_tr_b16 v[22:23], v9 offset:16896
    s_mov_b32 s35, 20480
    buffer_load_dwordx4 v[152:155], v7, s[20:23], s35 offen offset:2048
    s_waitcnt lgkmcnt(6)
    v_mfma_f32_32x32x16_bf16 v[192:207], v[92:95], v[40:43], v[192:207]
    ds_read_b64_tr_b16 v[24:25], v8 offset:18432
    ds_read_b64_tr_b16 v[26:27], v8 offset:18944
    s_mov_b32 s35, 20480
    buffer_load_dwordx4 v[156:159], v7, s[20:23], s35 offen offset:3072
    s_waitcnt lgkmcnt(6)
    v_mfma_f32_32x32x16_bf16 v[208:223], v[92:95], v[44:47], v[208:223]
    ds_read_b64_tr_b16 v[28:29], v9 offset:18432
    ds_read_b64_tr_b16 v[30:31], v9 offset:18944
    s_waitcnt lgkmcnt(6)
    v_mfma_f32_32x32x16_bf16 v[192:207], v[96:99], v[16:19], v[192:207]
    ds_read_b64_tr_b16 v[32:33], v8 offset:20480
    ds_read_b64_tr_b16 v[34:35], v8 offset:20992
    s_add_u32 s34, s32, 1572864
    s_add_u32 m0, s33, 49152
    s_nop 0
    buffer_load_dwordx4 v6, s[16:19], s34 offen lds
    s_waitcnt lgkmcnt(6)
    v_mfma_f32_32x32x16_bf16 v[208:223], v[96:99], v[20:23], v[208:223]
    ds_read_b64_tr_b16 v[36:37], v9 offset:20480
    ds_read_b64_tr_b16 v[38:39], v9 offset:20992
    s_mov_b32 s35, 24576
    buffer_load_dwordx4 v[160:163], v7, s[20:23], s35 offen offset:0
    s_waitcnt lgkmcnt(6)
    v_mfma_f32_32x32x16_bf16 v[192:207], v[100:103], v[24:27], v[192:207]
    ds_read_b64_tr_b16 v[40:41], v8 offset:22528
    ds_read_b64_tr_b16 v[42:43], v8 offset:23040
    s_mov_b32 s35, 24576
    buffer_load_dwordx4 v[164:167], v7, s[20:23], s35 offen offset:1024
    s_waitcnt lgkmcnt(6)
    v_mfma_f32_32x32x16_bf16 v[208:223], v[100:103], v[28:31], v[208:223]
    ds_read_b64_tr_b16 v[44:45], v9 offset:22528
    ds_read_b64_tr_b16 v[46:47], v9 offset:23040
    s_waitcnt vmcnt(15)
    s_barrier
    s_waitcnt lgkmcnt(6)
    v_mfma_f32_32x32x16_bf16 v[192:207], v[104:107], v[32:35], v[192:207]
    ds_read_b64_tr_b16 v[16:17], v8 offset:24576
    ds_read_b64_tr_b16 v[18:19], v8 offset:25088
    s_add_u32 s34, s32, 1605632
    s_add_u32 m0, s33, 50176
    s_nop 0
    buffer_load_dwordx4 v6, s[16:19], s34 offen lds
    s_waitcnt lgkmcnt(6)
    v_mfma_f32_32x32x16_bf16 v[208:223], v[104:107], v[36:39], v[208:223]
    ds_read_b64_tr_b16 v[20:21], v9 offset:24576
    ds_read_b64_tr_b16 v[22:23], v9 offset:25088
    s_mov_b32 s35, 24576
    buffer_load_dwordx4 v[168:171], v7, s[20:23], s35 offen offset:2048
    s_waitcnt lgkmcnt(6)
    v_mfma_f32_32x32x16_bf16 v[192:207], v[108:111], v[40:43], v[192:207]
    ds_read_b64_tr_b16 v[24:25], v8 offset:26624
    ds_read_b64_tr_b16 v[26:27], v8 offset:27136
    s_mov_b32 s35, 24576
    buffer_load_dwordx4 v[172:175], v7, s[20:23], s35 offen offset:3072
    s_waitcnt lgkmcnt(6)
    v_mfma_f32_32x32x16_bf16 v[208:223], v[108:111], v[44:47], v[208:223]
    ds_read_b64_tr_b16 v[28:29], v9 offset:26624
    ds_read_b64_tr_b16 v[30:31], v9 offset:27136
    s_waitcnt lgkmcnt(6)
    v_mfma_f32_32x32x16_bf16 v[192:207], v[112:115], v[16:19], v[192:207]
    ds_read_b64_tr_b16 v[32:33], v8 offset:28672
    ds_read_b64_tr_b16 v[34:35], v8 offset:29184
    s_add_u32 s34, s32, 1835008
    s_add_u32 m0, s33, 57344
    s_nop 0
    buffer_load_dwordx4 v6, s[16:19], s34 offen lds
    s_waitcnt lgkmcnt(6)
    v_mfma_f32_32x32x16_bf16 v[208:223], v[112:115], v[20:23], v[208:223]
    ds_read_b64_tr_b16 v[36:37], v9 offset:28672
    ds_read_b64_tr_b16 v[38:39], v9 offset:29184
    s_mov_b32 s35, 28672
    buffer_load_dwordx4 v[176:179], v7, s[20:23], s35 offen offset:0
    s_waitcnt lgkmcnt(6)
    v_mfma_f32_32x32x16_bf16 v[192:207], v[116:119], v[24:27], v[192:207]
    ds_read_b64_tr_b16 v[40:41], v8 offset:30720
    ds_read_b64_tr_b16 v[42:43], v8 offset:31232
    s_mov_b32 s35, 28672
    buffer_load_dwordx4 v[180:183], v7, s[20:23], s35 offen offset:1024
    s_waitcnt lgkmcnt(6)
    v_mfma_f32_32x32x16_bf16 v[208:223], v[116:119], v[28:31], v[208:223]
    ds_read_b64_tr_b16 v[44:45], v9 offset:30720
    ds_read_b64_tr_b16 v[46:47], v9 offset:31232
    s_waitcnt vmcnt(15)
    s_barrier
    s_waitcnt lgkmcnt(6)
    v_mfma_f32_32x32x16_bf16 v[192:207], v[120:123], v[32:35], v[192:207]
    ds_read_b64_tr_b16 v[16:17], v8 offset:32768
    ds_read_b64_tr_b16 v[18:19], v8 offset:33280
    s_add_u32 s34, s32, 1867776
    s_add_u32 m0, s33, 58368
    s_nop 0
    buffer_load_dwordx4 v6, s[16:19], s34 offen lds
    s_waitcnt lgkmcnt(6)
    v_mfma_f32_32x32x16_bf16 v[208:223], v[120:123], v[36:39], v[208:223]
    ds_read_b64_tr_b16 v[20:21], v9 offset:32768
    ds_read_b64_tr_b16 v[22:23], v9 offset:33280
    s_mov_b32 s35, 28672
    buffer_load_dwordx4 v[184:187], v7, s[20:23], s35 offen offset:2048
    s_waitcnt lgkmcnt(6)
    v_mfma_f32_32x32x16_bf16 v[192:207], v[124:127], v[40:43], v[192:207]
    ds_read_b64_tr_b16 v[24:25], v8 offset:34816
    ds_read_b64_tr_b16 v[26:27], v8 offset:35328
    s_mov_b32 s35, 28672
    buffer_load_dwordx4 v[188:191], v7, s[20:23], s35 offen offset:3072
    s_waitcnt lgkmcnt(6)
    v_mfma_f32_32x32x16_bf16 v[208:223], v[124:127], v[44:47], v[208:223]
    ds_read_b64_tr_b16 v[28:29], v9 offset:34816
    ds_read_b64_tr_b16 v[30:31], v9 offset:35328
    s_waitcnt lgkmcnt(6)
    v_mfma_f32_32x32x16_bf16 v[192:207], v[128:131], v[16:19], v[192:207]
    ds_read_b64_tr_b16 v[32:33], v8 offset:36864
    ds_read_b64_tr_b16 v[34:35], v8 offset:37376
    s_add_u32 s34, s32, 128
    s_add_u32 m0, s33, 65536
    s_nop 0
    buffer_load_dwordx4 v6, s[16:19], s34 offen lds
    s_waitcnt lgkmcnt(6)
    v_mfma_f32_32x32x16_bf16 v[208:223], v[128:131], v[20:23], v[208:223]
    ds_read_b64_tr_b16 v[36:37], v9 offset:36864
    ds_read_b64_tr_b16 v[38:39], v9 offset:37376
    s_waitcnt lgkmcnt(6)
    v_mfma_f32_32x32x16_bf16 v[192:207], v[132:135], v[24:27], v[192:207]
    ds_read_b64_tr_b16 v[40:41], v8 offset:38912
    ds_read_b64_tr_b16 v[42:43], v8 offset:39424
    s_add_u32 s34, s32, 32896
    s_add_u32 m0, s33, 66560
    s_nop 0
    buffer_load_dwordx4 v6, s[16:19], s34 offen lds
    s_waitcnt lgkmcnt(6)
    v_mfma_f32_32x32x16_bf16 v[208:223], v[132:135], v[28:31], v[208:223]
    ds_read_b64_tr_b16 v[44:45], v9 offset:38912
    ds_read_b64_tr_b16 v[46:47], v9 offset:39424
    s_waitcnt vmcnt(14)
    s_barrier
    s_waitcnt lgkmcnt(6)
    v_mfma_f32_32x32x16_bf16 v[192:207], v[136:139], v[32:35], v[192:207]
    ds_read_b64_tr_b16 v[16:17], v8 offset:40960
    ds_read_b64_tr_b16 v[18:19], v8 offset:41472
    s_add_u32 s34, s32, 262272
    s_add_u32 m0, s33, 73728
    s_nop 0
    buffer_load_dwordx4 v6, s[16:19], s34 offen lds
    s_waitcnt lgkmcnt(6)
    v_mfma_f32_32x32x16_bf16 v[208:223], v[136:139], v[36:39], v[208:223]
    ds_read_b64_tr_b16 v[20:21], v9 offset:40960
    ds_read_b64_tr_b16 v[22:23], v9 offset:41472
    s_waitcnt lgkmcnt(6)
    v_mfma_f32_32x32x16_bf16 v[192:207], v[140:143], v[40:43], v[192:207]
    ds_read_b64_tr_b16 v[24:25], v8 offset:43008
    ds_read_b64_tr_b16 v[26:27], v8 offset:43520
    s_add_u32 s34, s32, 295040
    s_add_u32 m0, s33, 74752
    s_nop 0
    buffer_load_dwordx4 v6, s[16:19], s34 offen lds
    s_waitcnt lgkmcnt(6)
    v_mfma_f32_32x32x16_bf16 v[208:223], v[140:143], v[44:47], v[208:223]
    ds_read_b64_tr_b16 v[28:29], v9 offset:43008
    ds_read_b64_tr_b16 v[30:31], v9 offset:43520
    s_waitcnt lgkmcnt(6)
    v_mfma_f32_32x32x16_bf16 v[192:207], v[144:147], v[16:19], v[192:207]
    ds_read_b64_tr_b16 v[32:33], v8 offset:45056
    ds_read_b64_tr_b16 v[34:35], v8 offset:45568
    s_add_u32 s34, s32, 524416
    s_add_u32 m0, s33, 81920
    s_nop 0
    buffer_load_dwordx4 v6, s[16:19], s34 offen lds
    s_waitcnt lgkmcnt(6)
    v_mfma_f32_32x32x16_bf16 v[208:223], v[144:147], v[20:23], v[208:223]
    ds_read_b64_tr_b16 v[36:37], v9 offset:45056
    ds_read_b64_tr_b16 v[38:39], v9 offset:45568
    s_waitcnt lgkmcnt(6)
    v_mfma_f32_32x32x16_bf16 v[192:207], v[148:151], v[24:27], v[192:207]
    ds_read_b64_tr_b16 v[40:41], v8 offset:47104
    ds_read_b64_tr_b16 v[42:43], v8 offset:47616
    s_add_u32 s34, s32, 557184
    s_add_u32 m0, s33, 82944
    s_nop 0
    buffer_load_dwordx4 v6, s[16:19], s34 offen lds
    s_waitcnt lgkmcnt(6)
    v_mfma_f32_32x32x16_bf16 v[208:223], v[148:151], v[28:31], v[208:223]
    ds_read_b64_tr_b16 v[44:45], v9 offset:47104
    ds_read_b64_tr_b16 v[46:47], v9 offset:47616
    s_waitcnt vmcnt(12)
    s_barrier
    s_waitcnt lgkmcnt(6)
    v_mfma_f32_32x32x16_bf16 v[192:207], v[152:155], v[32:35], v[192:207]
    ds_read_b64_tr_b16 v[16:17], v8 offset:49152
    ds_read_b64_tr_b16 v[18:19], v8 offset:49664
    s_add_u32 s34, s32, 786560
    s_add_u32 m0, s33, 90112
    s_nop 0
    buffer_load_dwordx4 v6, s[16:19], s34 offen lds
    s_waitcnt lgkmcnt(6)
    v_mfma_f32_32x32x16_bf16 v[208:223], v[152:155], v[36:39], v[208:223]
    ds_read_b64_tr_b16 v[20:21], v9 offset:49152
    ds_read_b64_tr_b16 v[22:23], v9 offset:49664
    s_waitcnt lgkmcnt(6)
    v_mfma_f32_32x32x16_bf16 v[192:207], v[156:159], v[40:43], v[192:207]
    ds_read_b64_tr_b16 v[24:25], v8 offset:51200
    ds_read_b64_tr_b16 v[26:27], v8 offset:51712
    s_add_u32 s34, s32, 819328
    s_add_u32 m0, s33, 91136
    s_nop 0
    buffer_load_dwordx4 v6, s[16:19], s34 offen lds
    s_waitcnt lgkmcnt(6)
    v_mfma_f32_32x32x16_bf16 v[208:223], v[156:159], v[44:47], v[208:223]
    ds_read_b64_tr_b16 v[28:29], v9 offset:51200
    ds_read_b64_tr_b16 v[30:31], v9 offset:51712
    s_waitcnt lgkmcnt(6)
    v_mfma_f32_32x32x16_bf16 v[192:207], v[160:163], v[16:19], v[192:207]
    ds_read_b64_tr_b16 v[32:33], v8 offset:53248
    ds_read_b64_tr_b16 v[34:35], v8 offset:53760
    s_add_u32 s34, s32, 1048704
    s_add_u32 m0, s33, 98304
    s_nop 0
    buffer_load_dwordx4 v6, s[16:19], s34 offen lds
    s_waitcnt lgkmcnt(6)
    v_mfma_f32_32x32x16_bf16 v[208:223], v[160:163], v[20:23], v[208:223]
    ds_read_b64_tr_b16 v[36:37], v9 offset:53248
    ds_read_b64_tr_b16 v[38:39], v9 offset:53760
    s_waitcnt lgkmcnt(6)
    v_mfma_f32_32x32x16_bf16 v[192:207], v[164:167], v[24:27], v[192:207]
    ds_read_b64_tr_b16 v[40:41], v8 offset:55296
    ds_read_b64_tr_b16 v[42:43], v8 offset:55808
    s_add_u32 s34, s32, 1081472
    s_add_u32 m0, s33, 99328
    s_nop 0
    buffer_load_dwordx4 v6, s[16:19], s34 offen lds
    s_waitcnt lgkmcnt(6)
    v_mfma_f32_32x32x16_bf16 v[208:223], v[164:167], v[28:31], v[208:223]
    ds_read_b64_tr_b16 v[44:45], v9 offset:55296
    ds_read_b64_tr_b16 v[46:47], v9 offset:55808
    s_waitcnt vmcnt(10)
    s_barrier
    s_waitcnt lgkmcnt(6)
    v_mfma_f32_32x32x16_bf16 v[192:207], v[168:171], v[32:35], v[192:207]
    ds_read_b64_tr_b16 v[16:17], v8 offset:57344
    ds_read_b64_tr_b16 v[18:19], v8 offset:57856
    s_add_u32 s34, s32, 1310848
    s_add_u32 m0, s33, 106496
    s_nop 0
    buffer_load_dwordx4 v6, s[16:19], s34 offen lds
    s_waitcnt lgkmcnt(6)
    v_mfma_f32_32x32x16_bf16 v[208:223], v[168:171], v[36:39], v[208:223]
    ds_read_b64_tr_b16 v[20:21], v9 offset:57344
    ds_read_b64_tr_b16 v[22:23], v9 offset:57856
    s_waitcnt lgkmcnt(6)
    v_mfma_f32_32x32x16_bf16 v[192:207], v[172:175], v[40:43], v[192:207]
    ds_read_b64_tr_b16 v[24:25], v8 offset:59392
    ds_read_b64_tr_b16 v[26:27], v8 offset:59904
    s_add_u32 s34, s32, 1343616
    s_add_u32 m0, s33, 107520
    s_nop 0
    buffer_load_dwordx4 v6, s[16:19], s34 offen lds
    s_waitcnt lgkmcnt(6)
    v_mfma_f32_32x32x16_bf16 v[208:223], v[172:175], v[44:47], v[208:223]
    ds_read_b64_tr_b16 v[28:29], v9 offset:59392
    ds_read_b64_tr_b16 v[30:31], v9 offset:59904
    s_waitcnt lgkmcnt(6)
    v_mfma_f32_32x32x16_bf16 v[192:207], v[176:179], v[16:19], v[192:207]
    ds_read_b64_tr_b16 v[32:33], v8 offset:61440
    ds_read_b64_tr_b16 v[34:35], v8 offset:61952
    s_add_u32 s34, s32, 1572992
    s_add_u32 m0, s33, 114688
    s_nop 0
    buffer_load_dwordx4 v6, s[16:19], s34 offen lds
    s_waitcnt lgkmcnt(6)
    v_mfma_f32_32x32x16_bf16 v[208:223], v[176:179], v[20:23], v[208:223]
    ds_read_b64_tr_b16 v[36:37], v9 offset:61440
    ds_read_b64_tr_b16 v[38:39], v9 offset:61952
    s_add_u32 s34, s32, 1605760
    s_add_u32 m0, s33, 115712
    s_nop 0
    buffer_load_dwordx4 v6, s[16:19], s34 offen lds
    s_waitcnt lgkmcnt(6)
    v_mfma_f32_32x32x16_bf16 v[192:207], v[180:183], v[24:27], v[192:207]
    ds_read_b64_tr_b16 v[40:41], v8 offset:63488
    ds_read_b64_tr_b16 v[42:43], v8 offset:64000
    s_add_u32 s34, s32, 1835136
    s_add_u32 m0, s33, 122880
    s_nop 0
    buffer_load_dwordx4 v6, s[16:19], s34 offen lds
    s_waitcnt lgkmcnt(6)
    v_mfma_f32_32x32x16_bf16 v[208:223], v[180:183], v[28:31], v[208:223]
    ds_read_b64_tr_b16 v[44:45], v9 offset:63488
    ds_read_b64_tr_b16 v[46:47], v9 offset:64000
    s_waitcnt lgkmcnt(6)
    v_mfma_f32_32x32x16_bf16 v[192:207], v[184:187], v[32:35], v[192:207]
    s_add_u32 s34, s32, 1867904
    s_add_u32 m0, s33, 123904
    s_nop 0
    buffer_load_dwordx4 v6, s[16:19], s34 offen lds
    s_waitcnt lgkmcnt(4)
    v_mfma_f32_32x32x16_bf16 v[208:223], v[184:187], v[36:39], v[208:223]
    buffer_load_dwordx2 v[56:57], v52, s[56:59], s62 offen offset:0 sc1
    s_waitcnt lgkmcnt(2)
    v_mfma_f32_32x32x16_bf16 v[192:207], v[188:191], v[40:43], v[192:207]
    buffer_load_dwordx2 v[58:59], v52, s[56:59], s62 offen offset:256 sc1
    s_waitcnt lgkmcnt(0)
    v_mfma_f32_32x32x16_bf16 v[208:223], v[188:191], v[44:47], v[208:223]
    v_lshrrev_b32 v54, 5, v2
    v_lshlrev_b32 v54, 4, v54
    s_lshl_b32 s37, s10, 7
    s_add_u32 s37, s37, 131072
    v_add_u32 v54, s37, v54
    ds_read_b128 v[16:19], v54 offset:0
    ds_read_b128 v[224:227], v54 offset:512
    ds_read_b128 v[20:23], v54 offset:32
    ds_read_b128 v[228:231], v54 offset:544
    ds_read_b128 v[24:27], v54 offset:64
    ds_read_b128 v[232:235], v54 offset:576
    ds_read_b128 v[28:31], v54 offset:96
    ds_read_b128 v[236:239], v54 offset:608
    s_waitcnt vmcnt(0) lgkmcnt(0)
    s_mov_b32 s61, 0
k34_chk0:
    v_min_f32 v51, v56, v58
    v_cmp_nlt_f32 vcc, 0, v51
    s_cbranch_vccz k34_chk0_ok
    buffer_load_dwordx2 v[56:57], v52, s[56:59], s62 offen offset:0 sc1
    buffer_load_dwordx2 v[58:59], v52, s[56:59], s62 offen offset:256 sc1
    s_waitcnt vmcnt(0)
    s_add_u32 s61, s61, 1
    s_cmp_lt_u32 s61, 100000
    s_cbranch_scc1 k34_chk0
k34_chk0_ok:
    s_lshl_b32 s38, s13, 2
    s_add_u32 s37, s38, 0
    s_mul_i32 s37, s37, 56
    s_add_u32 s37, s37, s15
    s_lshl_b32 s37, s37, 11
    v_pk_fma_f32 v[192:193], v[192:193], v[56:57], v[224:225] op_sel:[0,0,0] op_sel_hi:[1,0,1]
    v_pk_fma_f32 v[192:193], v[16:17], v[56:57], v[192:193] op_sel:[0,1,0] op_sel_hi:[1,1,1] neg_lo:[0,1,0] neg_hi:[0,1,0]
    v_cvt_pk_bf16_f32 v32, v192, v193
    v_pk_max_i16 v32, v32, 0
    v_pk_fma_f32 v[194:195], v[194:195], v[56:57], v[226:227] op_sel:[0,0,0] op_sel_hi:[1,0,1]
    v_pk_fma_f32 v[194:195], v[18:19], v[56:57], v[194:195] op_sel:[0,1,0] op_sel_hi:[1,1,1] neg_lo:[0,1,0] neg_hi:[0,1,0]
    v_cvt_pk_bf16_f32 v33, v194, v195
    v_pk_max_i16 v33, v33, 0
    s_mov_b32 s60, 0
    buffer_load_dwordx4 a[0:3], v7, s[48:51], s60 offen offset:0
    v_pk_fma_f32 v[196:197], v[196:197], v[56:57], v[228:229] op_sel:[0,0,0] op_sel_hi:[1,0,1]
    v_pk_fma_f32 v[196:197], v[20:21], v[56:57], v[196:197] op_sel:[0,1,0] op_sel_hi:[1,1,1] neg_lo:[0,1,0] neg_hi:[0,1,0]
    v_cvt_pk_bf16_f32 v34, v196, v197
    v_pk_max_i16 v34, v34, 0
    v_pk_fma_f32 v[198:199], v[198:199], v[56:57], v[230:231] op_sel:[0,0,0] op_sel_hi:[1,0,1]
    v_pk_fma_f32 v[198:199], v[22:23], v[56:57], v[198:199] op_sel:[0,1,0] op_sel_hi:[1,1,1] neg_lo:[0,1,0] neg_hi:[0,1,0]
    v_cvt_pk_bf16_f32 v35, v198, v199
    v_pk_max_i16 v35, v35, 0
    s_mov_b32 s60, 0
    buffer_load_dwordx4 a[4:7], v7, s[48:51], s60 offen offset:1024
    v_pk_fma_f32 v[200:201], v[200:201], v[56:57], v[232:233] op_sel:[0,0,0] op_sel_hi:[1,0,1]
    v_pk_fma_f32 v[200:201], v[24:25], v[56:57], v[200:201] op_sel:[0,1,0] op_sel_hi:[1,1,1] neg_lo:[0,1,0] neg_hi:[0,1,0]
    v_cvt_pk_bf16_f32 v36, v200, v201
    v_pk_max_i16 v36, v36, 0
    v_pk_fma_f32 v[202:203], v[202:203], v[56:57], v[234:235] op_sel:[0,0,0] op_sel_hi:[1,0,1]
    v_pk_fma_f32 v[202:203], v[26:27], v[56:57], v[202:203] op_sel:[0,1,0] op_sel_hi:[1,1,1] neg_lo:[0,1,0] neg_hi:[0,1,0]
    v_cvt_pk_bf16_f32 v37, v202, v203
    v_pk_max_i16 v37, v37, 0
    s_mov_b32 s60, 0
    buffer_load_dwordx4 a[8:11], v7, s[48:51], s60 offen offset:2048
    v_pk_fma_f32 v[204:205], v[204:205], v[56:57], v[236:237] op_sel:[0,0,0] op_sel_hi:[1,0,1]
    v_pk_fma_f32 v[204:205], v[28:29], v[56:57], v[204:205] op_sel:[0,1,0] op_sel_hi:[1,1,1] neg_lo:[0,1,0] neg_hi:[0,1,0]
    v_cvt_pk_bf16_f32 v38, v204, v205
    v_pk_max_i16 v38, v38, 0
    v_pk_fma_f32 v[206:207], v[206:207], v[56:57], v[238:239] op_sel:[0,0,0] op_sel_hi:[1,0,1]
    v_pk_fma_f32 v[206:207], v[30:31], v[56:57], v[206:207] op_sel:[0,1,0] op_sel_hi:[1,1,1] neg_lo:[0,1,0] neg_hi:[0,1,0]
    v_cvt_pk_bf16_f32 v39, v206, v207
    v_pk_max_i16 v39, v39, 0
    s_mov_b32 s60, 0
    buffer_load_dwordx4 a[12:15], v7, s[48:51], s60 offen offset:3072
    buffer_store_dwordx4 v[32:35], v7, s[28:31], s37 offen sc1
    buffer_store_dwordx4 v[36:39], v7, s[28:31], s37 offen offset:1024 sc1
    s_lshl_b32 s38, s13, 2
    s_add_u32 s37, s38, 1
    s_mul_i32 s37, s37, 56
    s_add_u32 s37, s37, s15
    s_lshl_b32 s37, s37, 11
    v_pk_fma_f32 v[208:209], v[208:209], v[58:59], v[224:225] op_sel:[0,0,0] op_sel_hi:[1,0,1]
    v_pk_fma_f32 v[208:209], v[16:17], v[58:59], v[208:209] op_sel:[0,1,0] op_sel_hi:[1,1,1] neg_lo:[0,1,0] neg_hi:[0,1,0]
    v_cvt_pk_bf16_f32 v40, v208, v209
    v_pk_max_i16 v40, v40, 0
    v_pk_fma_f32 v[210:211], v[210:211], v[58:59], v[226:227] op_sel:[0,0,0] op_sel_hi:[1,0,1]
    v_pk_fma_f32 v[210:211], v[18:19], v[58:59], v[210:211] op_sel:[0,1,0] op_sel_hi:[1,1,1] neg_lo:[0,1,0] neg_hi:[0,1,0]
    v_cvt_pk_bf16_f32 v41, v210, v211
    v_pk_max_i16 v41, v41, 0
    s_mov_b32 s60, 4096
    buffer_load_dwordx4 a[16:19], v7, s[48:51], s60 offen offset:0
    v_pk_fma_f32 v[212:213], v[212:213], v[58:59], v[228:229] op_sel:[0,0,0] op_sel_hi:[1,0,1]
    v_pk_fma_f32 v[212:213], v[20:21], v[58:59], v[212:213] op_sel:[0,1,0] op_sel_hi:[1,1,1] neg_lo:[0,1,0] neg_hi:[0,1,0]
    v_cvt_pk_bf16_f32 v42, v212, v213
    v_pk_max_i16 v42, v42, 0
    v_pk_fma_f32 v[214:215], v[214:215], v[58:59], v[230:231] op_sel:[0,0,0] op_sel_hi:[1,0,1]
    v_pk_fma_f32 v[214:215], v[22:23], v[58:59], v[214:215] op_sel:[0,1,0] op_sel_hi:[1,1,1] neg_lo:[0,1,0] neg_hi:[0,1,0]
    v_cvt_pk_bf16_f32 v43, v214, v215
    v_pk_max_i16 v43, v43, 0
    s_mov_b32 s60, 4096
    buffer_load_dwordx4 a[20:23], v7, s[48:51], s60 offen offset:1024
    v_pk_fma_f32 v[216:217], v[216:217], v[58:59], v[232:233] op_sel:[0,0,0] op_sel_hi:[1,0,1]
    v_pk_fma_f32 v[216:217], v[24:25], v[58:59], v[216:217] op_sel:[0,1,0] op_sel_hi:[1,1,1] neg_lo:[0,1,0] neg_hi:[0,1,0]
    v_cvt_pk_bf16_f32 v44, v216, v217
    v_pk_max_i16 v44, v44, 0
    v_pk_fma_f32 v[218:219], v[218:219], v[58:59], v[234:235] op_sel:[0,0,0] op_sel_hi:[1,0,1]
    v_pk_fma_f32 v[218:219], v[26:27], v[58:59], v[218:219] op_sel:[0,1,0] op_sel_hi:[1,1,1] neg_lo:[0,1,0] neg_hi:[0,1,0]
    v_cvt_pk_bf16_f32 v45, v218, v219
    v_pk_max_i16 v45, v45, 0
    s_mov_b32 s60, 4096
    buffer_load_dwordx4 a[24:27], v7, s[48:51], s60 offen offset:2048
    v_pk_fma_f32 v[220:221], v[220:221], v[58:59], v[236:237] op_sel:[0,0,0] op_sel_hi:[1,0,1]
    v_pk_fma_f32 v[220:221], v[28:29], v[58:59], v[220:221] op_sel:[0,1,0] op_sel_hi:[1,1,1] neg_lo:[0,1,0] neg_hi:[0,1,0]
    v_cvt_pk_bf16_f32 v46, v220, v221
    v_pk_max_i16 v46, v46, 0
    v_pk_fma_f32 v[222:223], v[222:223], v[58:59], v[238:239] op_sel:[0,0,0] op_sel_hi:[1,0,1]
    v_pk_fma_f32 v[222:223], v[30:31], v[58:59], v[222:223] op_sel:[0,1,0] op_sel_hi:[1,1,1] neg_lo:[0,1,0] neg_hi:[0,1,0]
    v_cvt_pk_bf16_f32 v47, v222, v223
    v_pk_max_i16 v47, v47, 0
    s_mov_b32 s60, 4096
    buffer_load_dwordx4 a[28:31], v7, s[48:51], s60 offen offset:3072
    buffer_store_dwordx4 v[40:43], v7, s[28:31], s37 offen sc1
    buffer_store_dwordx4 v[44:47], v7, s[28:31], s37 offen offset:1024 sc1
    s_barrier
    ds_read_b64_tr_b16 v[16:17], v10 offset:0
    ds_read_b64_tr_b16 v[18:19], v10 offset:512
    ds_read_b64_tr_b16 v[20:21], v11 offset:0
    ds_read_b64_tr_b16 v[22:23], v11 offset:512
    ds_read_b64_tr_b16 v[24:25], v10 offset:2048
    ds_read_b64_tr_b16 v[26:27], v10 offset:2560
    ds_read_b64_tr_b16 v[28:29], v11 offset:2048
    ds_read_b64_tr_b16 v[30:31], v11 offset:2560
    s_waitcnt lgkmcnt(6)
    v_mfma_f32_32x32x16_bf16 v[224:239], v[64:67], v[16:19], 0
    ds_read_b64_tr_b16 v[32:33], v10 offset:4096
    ds_read_b64_tr_b16 v[34:35], v10 offset:4608
    s_mov_b32 s60, 8192
    buffer_load_dwordx4 a[32:35], v7, s[48:51], s60 offen offset:0
    s_waitcnt lgkmcnt(6)
    v_mfma_f32_32x32x16_bf16 v[240:255], v[64:67], v[20:23], 0
    ds_read_b64_tr_b16 v[36:37], v11 offset:4096
    ds_read_b64_tr_b16 v[38:39], v11 offset:4608
    s_waitcnt lgkmcnt(6)
    v_mfma_f32_32x32x16_bf16 v[224:239], v[68:71], v[24:27], v[224:239]
    ds_read_b64_tr_b16 v[40:41], v10 offset:6144
    ds_read_b64_tr_b16 v[42:43], v10 offset:6656
    s_mov_b32 s60, 8192
    buffer_load_dwordx4 a[36:39], v7, s[48:51], s60 offen offset:1024
    s_waitcnt lgkmcnt(6)
    v_mfma_f32_32x32x16_bf16 v[240:255], v[68:71], v[28:31], v[240:255]
    ds_read_b64_tr_b16 v[44:45], v11 offset:6144
    ds_read_b64_tr_b16 v[46:47], v11 offset:6656
    s_barrier
    s_waitcnt lgkmcnt(6)
    v_mfma_f32_32x32x16_bf16 v[224:239], v[72:75], v[32:35], v[224:239]
    ds_read_b64_tr_b16 v[16:17], v10 offset:8192
    ds_read_b64_tr_b16 v[18:19], v10 offset:8704
    s_mov_b32 s60, 8192
    buffer_load_dwordx4 a[40:43], v7, s[48:51], s60 offen offset:2048
    s_waitcnt lgkmcnt(6)
    v_mfma_f32_32x32x16_bf16 v[240:255], v[72:75], v[36:39], v[240:255]
    ds_read_b64_tr_b16 v[20:21], v11 offset:8192
    ds_read_b64_tr_b16 v[22:23], v11 offset:8704
    s_waitcnt lgkmcnt(6)
    v_mfma_f32_32x32x16_bf16 v[224:239], v[76:79], v[40:43], v[224:239]
    ds_read_b64_tr_b16 v[24:25], v10 offset:10240
    ds_read_b64_tr_b16 v[26:27], v10 offset:10752
    s_mov_b32 s60, 8192
    buffer_load_dwordx4 a[44:47], v7, s[48:51], s60 offen offset:3072
    s_waitcnt lgkmcnt(6)
    v_mfma_f32_32x32x16_bf16 v[240:255], v[76:79], v[44:47], v[240:255]
    ds_read_b64_tr_b16 v[28:29], v11 offset:10240
    ds_read_b64_tr_b16 v[30:31], v11 offset:10752
    s_waitcnt lgkmcnt(6)
    v_mfma_f32_32x32x16_bf16 v[224:239], v[80:83], v[16:19], v[224:239]
    ds_read_b64_tr_b16 v[32:33], v10 offset:12288
    ds_read_b64_tr_b16 v[34:35], v10 offset:12800
    s_mov_b32 s60, 12288
    buffer_load_dwordx4 a[48:51], v7, s[48:51], s60 offen offset:0
    s_waitcnt lgkmcnt(6)
    v_mfma_f32_32x32x16_bf16 v[240:255], v[80:83], v[20:23], v[240:255]
    ds_read_b64_tr_b16 v[36:37], v11 offset:12288
    ds_read_b64_tr_b16 v[38:39], v11 offset:12800
    s_waitcnt lgkmcnt(6)
    v_mfma_f32_32x32x16_bf16 v[224:239], v[84:87], v[24:27], v[224:239]
    ds_read_b64_tr_b16 v[40:41], v10 offset:14336
    ds_read_b64_tr_b16 v[42:43], v10 offset:14848
    s_mov_b32 s60, 12288
    buffer_load_dwordx4 a[52:55], v7, s[48:51], s60 offen offset:1024
    s_waitcnt lgkmcnt(6)
    v_mfma_f32_32x32x16_bf16 v[240:255], v[84:87], v[28:31], v[240:255]
    ds_read_b64_tr_b16 v[44:45], v11 offset:14336
    ds_read_b64_tr_b16 v[46:47], v11 offset:14848
    s_barrier
    s_waitcnt lgkmcnt(6)
    v_mfma_f32_32x32x16_bf16 v[224:239], v[88:91], v[32:35], v[224:239]
    ds_read_b64_tr_b16 v[16:17], v10 offset:16384
    ds_read_b64_tr_b16 v[18:19], v10 offset:16896
    s_mov_b32 s60, 12288
    buffer_load_dwordx4 a[56:59], v7, s[48:51], s60 offen offset:2048
    s_waitcnt lgkmcnt(6)
    v_mfma_f32_32x32x16_bf16 v[240:255], v[88:91], v[36:39], v[240:255]
    ds_read_b64_tr_b16 v[20:21], v11 offset:16384
    ds_read_b64_tr_b16 v[22:23], v11 offset:16896
    s_waitcnt lgkmcnt(6)
    v_mfma_f32_32x32x16_bf16 v[224:239], v[92:95], v[40:43], v[224:239]
    ds_read_b64_tr_b16 v[24:25], v10 offset:18432
    ds_read_b64_tr_b16 v[26:27], v10 offset:18944
    s_mov_b32 s60, 12288
    buffer_load_dwordx4 a[60:63], v7, s[48:51], s60 offen offset:3072
    s_waitcnt lgkmcnt(6)
    v_mfma_f32_32x32x16_bf16 v[240:255], v[92:95], v[44:47], v[240:255]
    ds_read_b64_tr_b16 v[28:29], v11 offset:18432
    ds_read_b64_tr_b16 v[30:31], v11 offset:18944
    s_waitcnt lgkmcnt(6)
    v_mfma_f32_32x32x16_bf16 v[224:239], v[96:99], v[16:19], v[224:239]
    ds_read_b64_tr_b16 v[32:33], v10 offset:20480
    ds_read_b64_tr_b16 v[34:35], v10 offset:20992
    s_mov_b32 s60, 16384
    buffer_load_dwordx4 a[64:67], v7, s[48:51], s60 offen offset:0
    s_waitcnt lgkmcnt(6)
    v_mfma_f32_32x32x16_bf16 v[240:255], v[96:99], v[20:23], v[240:255]
    ds_read_b64_tr_b16 v[36:37], v11 offset:20480
    ds_read_b64_tr_b16 v[38:39], v11 offset:20992
    s_waitcnt lgkmcnt(6)
    v_mfma_f32_32x32x16_bf16 v[224:239], v[100:103], v[24:27], v[224:239]
    ds_read_b64_tr_b16 v[40:41], v10 offset:22528
    ds_read_b64_tr_b16 v[42:43], v10 offset:23040
    s_mov_b32 s60, 16384
    buffer_load_dwordx4 a[68:71], v7, s[48:51], s60 offen offset:1024
    s_waitcnt lgkmcnt(6)
    v_mfma_f32_32x32x16_bf16 v[240:255], v[100:103], v[28:31], v[240:255]
    ds_read_b64_tr_b16 v[44:45], v11 offset:22528
    ds_read_b64_tr_b16 v[46:47], v11 offset:23040
    s_barrier
    s_waitcnt lgkmcnt(6)
    v_mfma_f32_32x32x16_bf16 v[224:239], v[104:107], v[32:35], v[224:239]
    ds_read_b64_tr_b16 v[16:17], v10 offset:24576
    ds_read_b64_tr_b16 v[18:19], v10 offset:25088
    s_mov_b32 s60, 16384
    buffer_load_dwordx4 a[72:75], v7, s[48:51], s60 offen offset:2048
    s_waitcnt lgkmcnt(6)
    v_mfma_f32_32x32x16_bf16 v[240:255], v[104:107], v[36:39], v[240:255]
    ds_read_b64_tr_b16 v[20:21], v11 offset:24576
    ds_read_b64_tr_b16 v[22:23], v11 offset:25088
    s_waitcnt lgkmcnt(6)
    v_mfma_f32_32x32x16_bf16 v[224:239], v[108:111], v[40:43], v[224:239]
    ds_read_b64_tr_b16 v[24:25], v10 offset:26624
    ds_read_b64_tr_b16 v[26:27], v10 offset:27136
    s_mov_b32 s60, 16384
    buffer_load_dwordx4 a[76:79], v7, s[48:51], s60 offen offset:3072
    s_waitcnt lgkmcnt(6)
    v_mfma_f32_32x32x16_bf16 v[240:255], v[108:111], v[44:47], v[240:255]
    ds_read_b64_tr_b16 v[28:29], v11 offset:26624
    ds_read_b64_tr_b16 v[30:31], v11 offset:27136
    s_waitcnt lgkmcnt(6)
    v_mfma_f32_32x32x16_bf16 v[224:239], v[112:115], v[16:19], v[224:239]
    ds_read_b64_tr_b16 v[32:33], v10 offset:28672
    ds_read_b64_tr_b16 v[34:35], v10 offset:29184
    s_mov_b32 s60, 20480
    buffer_load_dwordx4 a[80:83], v7, s[48:51], s60 offen offset:0
    s_waitcnt lgkmcnt(6)
    v_mfma_f32_32x32x16_bf16 v[240:255], v[112:115], v[20:23], v[240:255]
    ds_read_b64_tr_b16 v[36:37], v11 offset:28672
    ds_read_b64_tr_b16 v[38:39], v11 offset:29184
    s_waitcnt lgkmcnt(6)
    v_mfma_f32_32x32x16_bf16 v[224:239], v[116:119], v[24:27], v[224:239]
    ds_read_b64_tr_b16 v[40:41], v10 offset:30720
    ds_read_b64_tr_b16 v[42:43], v10 offset:31232
    s_mov_b32 s60, 20480
    buffer_load_dwordx4 a[84:87], v7, s[48:51], s60 offen offset:1024
    s_waitcnt lgkmcnt(6)
    v_mfma_f32_32x32x16_bf16 v[240:255], v[116:119], v[28:31], v[240:255]
    ds_read_b64_tr_b16 v[44:45], v11 offset:30720
    ds_read_b64_tr_b16 v[46:47], v11 offset:31232
    s_barrier
    s_waitcnt lgkmcnt(6)
    v_mfma_f32_32x32x16_bf16 v[224:239], v[120:123], v[32:35], v[224:239]
    ds_read_b64_tr_b16 v[16:17], v10 offset:32768
    ds_read_b64_tr_b16 v[18:19], v10 offset:33280
    s_mov_b32 s60, 20480
    buffer_load_dwordx4 a[88:91], v7, s[48:51], s60 offen offset:2048
    s_waitcnt lgkmcnt(6)
    v_mfma_f32_32x32x16_bf16 v[240:255], v[120:123], v[36:39], v[240:255]
    ds_read_b64_tr_b16 v[20:21], v11 offset:32768
    ds_read_b64_tr_b16 v[22:23], v11 offset:33280
    s_waitcnt lgkmcnt(6)
    v_mfma_f32_32x32x16_bf16 v[224:239], v[124:127], v[40:43], v[224:239]
    ds_read_b64_tr_b16 v[24:25], v10 offset:34816
    ds_read_b64_tr_b16 v[26:27], v10 offset:35328
    s_mov_b32 s60, 20480
    buffer_load_dwordx4 a[92:95], v7, s[48:51], s60 offen offset:3072
    s_waitcnt lgkmcnt(6)
    v_mfma_f32_32x32x16_bf16 v[240:255], v[124:127], v[44:47], v[240:255]
    ds_read_b64_tr_b16 v[28:29], v11 offset:34816
    ds_read_b64_tr_b16 v[30:31], v11 offset:35328
    s_waitcnt lgkmcnt(6)
    v_mfma_f32_32x32x16_bf16 v[224:239], v[128:131], v[16:19], v[224:239]
    ds_read_b64_tr_b16 v[32:33], v10 offset:36864
    ds_read_b64_tr_b16 v[34:35], v10 offset:37376
    s_mov_b32 s60, 24576
    buffer_load_dwordx4 a[96:99], v7, s[48:51], s60 offen offset:0
    s_waitcnt lgkmcnt(6)
    v_mfma_f32_32x32x16_bf16 v[240:255], v[128:131], v[20:23], v[240:255]
    ds_read_b64_tr_b16 v[36:37], v11 offset:36864
    ds_read_b64_tr_b16 v[38:39], v11 offset:37376
    s_waitcnt lgkmcnt(6)
    v_mfma_f32_32x32x16_bf16 v[224:239], v[132:135], v[24:27], v[224:239]
    ds_read_b64_tr_b16 v[40:41], v10 offset:38912
    ds_read_b64_tr_b16 v[42:43], v10 offset:39424
    s_mov_b32 s60, 24576
    buffer_load_dwordx4 a[100:103], v7, s[48:51], s60 offen offset:1024
    s_waitcnt lgkmcnt(6)
    v_mfma_f32_32x32x16_bf16 v[240:255], v[132:135], v[28:31], v[240:255]
    ds_read_b64_tr_b16 v[44:45], v11 offset:38912
    ds_read_b64_tr_b16 v[46:47], v11 offset:39424
    s_barrier
    s_waitcnt lgkmcnt(6)
    v_mfma_f32_32x32x16_bf16 v[224:239], v[136:139], v[32:35], v[224:239]
    ds_read_b64_tr_b16 v[16:17], v10 offset:40960
    ds_read_b64_tr_b16 v[18:19], v10 offset:41472
    s_mov_b32 s60, 24576
    buffer_load_dwordx4 a[104:107], v7, s[48:51], s60 offen offset:2048
    s_waitcnt lgkmcnt(6)
    v_mfma_f32_32x32x16_bf16 v[240:255], v[136:139], v[36:39], v[240:255]
    ds_read_b64_tr_b16 v[20:21], v11 offset:40960
    ds_read_b64_tr_b16 v[22:23], v11 offset:41472
    s_waitcnt lgkmcnt(6)
    v_mfma_f32_32x32x16_bf16 v[224:239], v[140:143], v[40:43], v[224:239]
    ds_read_b64_tr_b16 v[24:25], v10 offset:43008
    ds_read_b64_tr_b16 v[26:27], v10 offset:43520
    s_mov_b32 s60, 24576
    buffer_load_dwordx4 a[108:111], v7, s[48:51], s60 offen offset:3072
    s_waitcnt lgkmcnt(6)
    v_mfma_f32_32x32x16_bf16 v[240:255], v[140:143], v[44:47], v[240:255]
    ds_read_b64_tr_b16 v[28:29], v11 offset:43008
    ds_read_b64_tr_b16 v[30:31], v11 offset:43520
    s_waitcnt lgkmcnt(6)
    v_mfma_f32_32x32x16_bf16 v[224:239], v[144:147], v[16:19], v[224:239]
    ds_read_b64_tr_b16 v[32:33], v10 offset:45056
    ds_read_b64_tr_b16 v[34:35], v10 offset:45568
    s_mov_b32 s60, 28672
    buffer_load_dwordx4 a[112:115], v7, s[48:51], s60 offen offset:0
    s_waitcnt lgkmcnt(6)
    v_mfma_f32_32x32x16_bf16 v[240:255], v[144:147], v[20:23], v[240:255]
    ds_read_b64_tr_b16 v[36:37], v11 offset:45056
    ds_read_b64_tr_b16 v[38:39], v11 offset:45568
    s_mov_b32 s60, 28672
    buffer_load_dwordx4 a[116:119], v7, s[48:51], s60 offen offset:1024
    s_waitcnt lgkmcnt(6)
    v_mfma_f32_32x32x16_bf16 v[224:239], v[148:151], v[24:27], v[224:239]
    ds_read_b64_tr_b16 v[40:41], v10 offset:47104
    ds_read_b64_tr_b16 v[42:43], v10 offset:47616
    s_mov_b32 s60, 28672
    buffer_load_dwordx4 a[120:123], v7, s[48:51], s60 offen offset:2048
    s_waitcnt lgkmcnt(6)
    v_mfma_f32_32x32x16_bf16 v[240:255], v[148:151], v[28:31], v[240:255]
    ds_read_b64_tr_b16 v[44:45], v11 offset:47104
    ds_read_b64_tr_b16 v[46:47], v11 offset:47616
    s_waitcnt vmcnt(23)
    s_barrier
    s_cmp_lg_u32 s10, 0
    s_cbranch_scc1 k34_noflag_9
    s_mul_i32 s3, s13, 14
    s_add_u32 s3, s3, s14
    s_add_u32 s3, s3, 0
    s_lshl_b32 s3, s3, 7
    v_mov_b32 v3, 0
    v_mov_b32 v4, 1
    s_mov_b64 exec, 1
    buffer_store_dword v4, v3, s[52:55], s3 offen sc1
    s_mov_b64 exec, -1
k34_noflag_9:
    s_waitcnt lgkmcnt(6)
    v_mfma_f32_32x32x16_bf16 v[224:239], v[152:155], v[32:35], v[224:239]
    ds_read_b64_tr_b16 v[16:17], v10 offset:49152
    ds_read_b64_tr_b16 v[18:19], v10 offset:49664
    s_mov_b32 s60, 28672
    buffer_load_dwordx4 a[124:127], v7, s[48:51], s60 offen offset:3072
    s_waitcnt lgkmcnt(6)
    v_mfma_f32_32x32x16_bf16 v[240:255], v[152:155], v[36:39], v[240:255]
    ds_read_b64_tr_b16 v[20:21], v11 offset:49152
    ds_read_b64_tr_b16 v[22:23], v11 offset:49664
    buffer_load_dwordx2 v[60:61], v52, s[56:59], s62 offen offset:512 sc1
    s_waitcnt lgkmcnt(6)
    v_mfma_f32_32x32x16_bf16 v[224:239], v[156:159], v[40:43], v[224:239]
    ds_read_b64_tr_b16 v[24:25], v10 offset:51200
    ds_read_b64_tr_b16 v[26:27], v10 offset:51712
    buffer_load_dwordx2 v[62:63], v52, s[56:59], s62 offen offset:768 sc1
    s_waitcnt lgkmcnt(6)
    v_mfma_f32_32x32x16_bf16 v[240:255], v[156:159], v[44:47], v[240:255]
    ds_read_b64_tr_b16 v[28:29], v11 offset:51200
    ds_read_b64_tr_b16 v[30:31], v11 offset:51712
    s_waitcnt lgkmcnt(6)
    v_mfma_f32_32x32x16_bf16 v[224:239], v[160:163], v[16:19], v[224:239]
    ds_read_b64_tr_b16 v[32:33], v10 offset:53248
    ds_read_b64_tr_b16 v[34:35], v10 offset:53760
    s_mov_b32 s60, 32768
    buffer_load_dwordx4 a[128:131], v7, s[48:51], s60 offen offset:0
    s_waitcnt lgkmcnt(6)
    v_mfma_f32_32x32x16_bf16 v[240:255], v[160:163], v[20:23], v[240:255]
    ds_read_b64_tr_b16 v[36:37], v11 offset:53248
    ds_read_b64_tr_b16 v[38:39], v11 offset:53760
    s_waitcnt lgkmcnt(6)
    v_mfma_f32_32x32x16_bf16 v[224:239], v[164:167], v[24:27], v[224:239]
    ds_read_b64_tr_b16 v[40:41], v10 offset:55296
    ds_read_b64_tr_b16 v[42:43], v10 offset:55808
    s_mov_b32 s60, 32768
    buffer_load_dwordx4 a[132:135], v7, s[48:51], s60 offen offset:1024
    s_waitcnt lgkmcnt(6)
    v_mfma_f32_32x32x16_bf16 v[240:255], v[164:167], v[28:31], v[240:255]
    ds_read_b64_tr_b16 v[44:45], v11 offset:55296
    ds_read_b64_tr_b16 v[46:47], v11 offset:55808
    s_barrier
    s_waitcnt lgkmcnt(6)
    v_mfma_f32_32x32x16_bf16 v[224:239], v[168:171], v[32:35], v[224:239]
    ds_read_b64_tr_b16 v[16:17], v10 offset:57344
    ds_read_b64_tr_b16 v[18:19], v10 offset:57856
    s_mov_b32 s60, 32768
    buffer_load_dwordx4 a[136:139], v7, s[48:51], s60 offen offset:2048
    s_waitcnt lgkmcnt(6)
    v_mfma_f32_32x32x16_bf16 v[240:255], v[168:171], v[36:39], v[240:255]
    ds_read_b64_tr_b16 v[20:21], v11 offset:57344
    ds_read_b64_tr_b16 v[22:23], v11 offset:57856
    s_waitcnt lgkmcnt(6)
    v_mfma_f32_32x32x16_bf16 v[224:239], v[172:175], v[40:43], v[224:239]
    ds_read_b64_tr_b16 v[24:25], v10 offset:59392
    ds_read_b64_tr_b16 v[26:27], v10 offset:59904
    s_mov_b32 s60, 32768
    buffer_load_dwordx4 a[140:143], v7, s[48:51], s60 offen offset:3072
    s_waitcnt lgkmcnt(6)
    v_mfma_f32_32x32x16_bf16 v[240:255], v[172:175], v[44:47], v[240:255]
    ds_read_b64_tr_b16 v[28:29], v11 offset:59392
    ds_read_b64_tr_b16 v[30:31], v11 offset:59904
    s_waitcnt lgkmcnt(6)
    v_mfma_f32_32x32x16_bf16 v[224:239], v[176:179], v[16:19], v[224:239]
    ds_read_b64_tr_b16 v[32:33], v10 offset:61440
    ds_read_b64_tr_b16 v[34:35], v10 offset:61952
    s_mov_b32 s60, 36864
    buffer_load_dwordx4 a[144:147], v7, s[48:51], s60 offen offset:0
    s_waitcnt lgkmcnt(6)
    v_mfma_f32_32x32x16_bf16 v[240:255], v[176:179], v[20:23], v[240:255]
    ds_read_b64_tr_b16 v[36:37], v11 offset:61440
    ds_read_b64_tr_b16 v[38:39], v11 offset:61952
    s_mov_b32 s60, 36864
    buffer_load_dwordx4 a[148:151], v7, s[48:51], s60 offen offset:1024
    s_waitcnt lgkmcnt(6)
    v_mfma_f32_32x32x16_bf16 v[224:239], v[180:183], v[24:27], v[224:239]
    ds_read_b64_tr_b16 v[40:41], v10 offset:63488
    ds_read_b64_tr_b16 v[42:43], v10 offset:64000
    s_waitcnt lgkmcnt(6)
    v_mfma_f32_32x32x16_bf16 v[240:255], v[180:183], v[28:31], v[240:255]
    ds_read_b64_tr_b16 v[44:45], v11 offset:63488
    ds_read_b64_tr_b16 v[46:47], v11 offset:64000
    s_mov_b32 s60, 36864
    buffer_load_dwordx4 a[152:155], v7, s[48:51], s60 offen offset:2048
    s_waitcnt lgkmcnt(6)
    v_mfma_f32_32x32x16_bf16 v[224:239], v[184:187], v[32:35], v[224:239]
    s_mov_b32 s60, 36864
    buffer_load_dwordx4 a[156:159], v7, s[48:51], s60 offen offset:3072
    s_waitcnt lgkmcnt(4)
    v_mfma_f32_32x32x16_bf16 v[240:255], v[184:187], v[36:39], v[240:255]
    s_waitcnt lgkmcnt(2)
    v_mfma_f32_32x32x16_bf16 v[224:239], v[188:191], v[40:43], v[224:239]
    buffer_load_dword v50, v53, s[52:55], s47 offen sc1
    s_waitcnt lgkmcnt(0)
    v_mfma_f32_32x32x16_bf16 v[240:255], v[188:191], v[44:47], v[240:255]
    ds_read_b128 v[16:19], v54 offset:0
    ds_read_b128 v[32:35], v54 offset:512
    ds_read_b128 v[20:23], v54 offset:32
    ds_read_b128 v[36:39], v54 offset:544
    ds_read_b128 v[24:27], v54 offset:64
    ds_read_b128 v[40:43], v54 offset:576
    ds_read_b128 v[28:31], v54 offset:96
    ds_read_b128 v[44:47], v54 offset:608
    s_waitcnt vmcnt(9) lgkmcnt(0)
    s_mov_b32 s61, 0
k34_chk1:
    v_min_f32 v51, v60, v62
    v_cmp_nlt_f32 vcc, 0, v51
    s_cbranch_vccz k34_chk1_ok
    buffer_load_dwordx2 v[60:61], v52, s[56:59], s62 offen offset:512 sc1
    buffer_load_dwordx2 v[62:63], v52, s[56:59], s62 offen offset:768 sc1
    s_waitcnt vmcnt(0)
    s_add_u32 s61, s61, 1
    s_cmp_lt_u32 s61, 100000
    s_cbranch_scc1 k34_chk1
k34_chk1_ok:
    s_lshl_b32 s38, s13, 2
    s_add_u32 s37, s38, 2
    s_mul_i32 s37, s37, 56
    s_add_u32 s37, s37, s15
    s_lshl_b32 s37, s37, 11
    v_pk_fma_f32 v[224:225], v[224:225], v[60:61], v[32:33] op_sel:[0,0,0] op_sel_hi:[1,0,1]
    v_pk_fma_f32 v[224:225], v[16:17], v[60:61], v[224:225] op_sel:[0,1,0] op_sel_hi:[1,1,1] neg_lo:[0,1,0] neg_hi:[0,1,0]
    v_cvt_pk_bf16_f32 v176, v224, v225
    v_pk_max_i16 v176, v176, 0
    v_pk_fma_f32 v[226:227], v[226:227], v[60:61], v[34:35] op_sel:[0,0,0] op_sel_hi:[1,0,1]
    v_pk_fma_f32 v[226:227], v[18:19], v[60:61], v[226:227] op_sel:[0,1,0] op_sel_hi:[1,1,1] neg_lo:[0,1,0] neg_hi:[0,1,0]
    v_cvt_pk_bf16_f32 v177, v226, v227
    v_pk_max_i16 v177, v177, 0
    s_mov_b32 s60, 40960
    buffer_load_dwordx4 a[160:163], v7, s[48:51], s60 offen offset:0
    v_pk_fma_f32 v[228:229], v[228:229], v[60:61], v[36:37] op_sel:[0,0,0] op_sel_hi:[1,0,1]
    v_pk_fma_f32 v[228:229], v[20:21], v[60:61], v[228:229] op_sel:[0,1,0] op_sel_hi:[1,1,1] neg_lo:[0,1,0] neg_hi:[0,1,0]
    v_cvt_pk_bf16_f32 v178, v228, v229
    v_pk_max_i16 v178, v178, 0
    v_pk_fma_f32 v[230:231], v[230:231], v[60:61], v[38:39] op_sel:[0,0,0] op_sel_hi:[1,0,1]
    v_pk_fma_f32 v[230:231], v[22:23], v[60:61], v[230:231] op_sel:[0,1,0] op_sel_hi:[1,1,1] neg_lo:[0,1,0] neg_hi:[0,1,0]
    v_cvt_pk_bf16_f32 v179, v230, v231
    v_pk_max_i16 v179, v179, 0
    s_mov_b32 s60, 40960
    buffer_load_dwordx4 a[164:167], v7, s[48:51], s60 offen offset:1024
    v_pk_fma_f32 v[232:233], v[232:233], v[60:61], v[40:41] op_sel:[0,0,0] op_sel_hi:[1,0,1]
    v_pk_fma_f32 v[232:233], v[24:25], v[60:61], v[232:233] op_sel:[0,1,0] op_sel_hi:[1,1,1] neg_lo:[0,1,0] neg_hi:[0,1,0]
    v_cvt_pk_bf16_f32 v180, v232, v233
    v_pk_max_i16 v180, v180, 0
    v_pk_fma_f32 v[234:235], v[234:235], v[60:61], v[42:43] op_sel:[0,0,0] op_sel_hi:[1,0,1]
    v_pk_fma_f32 v[234:235], v[26:27], v[60:61], v[234:235] op_sel:[0,1,0] op_sel_hi:[1,1,1] neg_lo:[0,1,0] neg_hi:[0,1,0]
    v_cvt_pk_bf16_f32 v181, v234, v235
    v_pk_max_i16 v181, v181, 0
    s_mov_b32 s60, 40960
    buffer_load_dwordx4 a[168:171], v7, s[48:51], s60 offen offset:2048
    v_pk_fma_f32 v[236:237], v[236:237], v[60:61], v[44:45] op_sel:[0,0,0] op_sel_hi:[1,0,1]
    v_pk_fma_f32 v[236:237], v[28:29], v[60:61], v[236:237] op_sel:[0,1,0] op_sel_hi:[1,1,1] neg_lo:[0,1,0] neg_hi:[0,1,0]
    v_cvt_pk_bf16_f32 v182, v236, v237
    v_pk_max_i16 v182, v182, 0
    v_pk_fma_f32 v[238:239], v[238:239], v[60:61], v[46:47] op_sel:[0,0,0] op_sel_hi:[1,0,1]
    v_pk_fma_f32 v[238:239], v[30:31], v[60:61], v[238:239] op_sel:[0,1,0] op_sel_hi:[1,1,1] neg_lo:[0,1,0] neg_hi:[0,1,0]
    v_cvt_pk_bf16_f32 v183, v238, v239
    v_pk_max_i16 v183, v183, 0
    s_mov_b32 s60, 40960
    buffer_load_dwordx4 a[172:175], v7, s[48:51], s60 offen offset:3072
    buffer_store_dwordx4 v[176:179], v7, s[28:31], s37 offen sc1
    buffer_store_dwordx4 v[180:183], v7, s[28:31], s37 offen offset:1024 sc1
    s_lshl_b32 s38, s13, 2
    s_add_u32 s37, s38, 3
    s_mul_i32 s37, s37, 56
    s_add_u32 s37, s37, s15
    s_lshl_b32 s37, s37, 11
    v_pk_fma_f32 v[240:241], v[240:241], v[62:63], v[32:33] op_sel:[0,0,0] op_sel_hi:[1,0,1]
    v_pk_fma_f32 v[240:241], v[16:17], v[62:63], v[240:241] op_sel:[0,1,0] op_sel_hi:[1,1,1] neg_lo:[0,1,0] neg_hi:[0,1,0]
    v_cvt_pk_bf16_f32 v184, v240, v241
    v_pk_max_i16 v184, v184, 0
    v_pk_fma_f32 v[242:243], v[242:243], v[62:63], v[34:35] op_sel:[0,0,0] op_sel_hi:[1,0,1]
    v_pk_fma_f32 v[242:243], v[18:19], v[62:63], v[242:243] op_sel:[0,1,0] op_sel_hi:[1,1,1] neg_lo:[0,1,0] neg_hi:[0,1,0]
    v_cvt_pk_bf16_f32 v185, v242, v243
    v_pk_max_i16 v185, v185, 0
    s_mov_b32 s60, 45056
    buffer_load_dwordx4 a[176:179], v7, s[48:51], s60 offen offset:0
    v_pk_fma_f32 v[244:245], v[244:245], v[62:63], v[36:37] op_sel:[0,0,0] op_sel_hi:[1,0,1]
    v_pk_fma_f32 v[244:245], v[20:21], v[62:63], v[244:245] op_sel:[0,1,0] op_sel_hi:[1,1,1] neg_lo:[0,1,0] neg_hi:[0,1,0]
    v_cvt_pk_bf16_f32 v186, v244, v245
    v_pk_max_i16 v186, v186, 0
    v_pk_fma_f32 v[246:247], v[246:247], v[62:63], v[38:39] op_sel:[0,0,0] op_sel_hi:[1,0,1]
    v_pk_fma_f32 v[246:247], v[22:23], v[62:63], v[246:247] op_sel:[0,1,0] op_sel_hi:[1,1,1] neg_lo:[0,1,0] neg_hi:[0,1,0]
    v_cvt_pk_bf16_f32 v187, v246, v247
    v_pk_max_i16 v187, v187, 0
    s_mov_b32 s60, 45056
    buffer_load_dwordx4 a[180:183], v7, s[48:51], s60 offen offset:1024
    v_pk_fma_f32 v[248:249], v[248:249], v[62:63], v[40:41] op_sel:[0,0,0] op_sel_hi:[1,0,1]
    v_pk_fma_f32 v[248:249], v[24:25], v[62:63], v[248:249] op_sel:[0,1,0] op_sel_hi:[1,1,1] neg_lo:[0,1,0] neg_hi:[0,1,0]
    v_cvt_pk_bf16_f32 v188, v248, v249
    v_pk_max_i16 v188, v188, 0
    v_pk_fma_f32 v[250:251], v[250:251], v[62:63], v[42:43] op_sel:[0,0,0] op_sel_hi:[1,0,1]
    v_pk_fma_f32 v[250:251], v[26:27], v[62:63], v[250:251] op_sel:[0,1,0] op_sel_hi:[1,1,1] neg_lo:[0,1,0] neg_hi:[0,1,0]
    v_cvt_pk_bf16_f32 v189, v250, v251
    v_pk_max_i16 v189, v189, 0
    s_mov_b32 s60, 45056
    buffer_load_dwordx4 a[184:187], v7, s[48:51], s60 offen offset:2048
    v_pk_fma_f32 v[252:253], v[252:253], v[62:63], v[44:45] op_sel:[0,0,0] op_sel_hi:[1,0,1]
    v_pk_fma_f32 v[252:253], v[28:29], v[62:63], v[252:253] op_sel:[0,1,0] op_sel_hi:[1,1,1] neg_lo:[0,1,0] neg_hi:[0,1,0]
    v_cvt_pk_bf16_f32 v190, v252, v253
    v_pk_max_i16 v190, v190, 0
    v_pk_fma_f32 v[254:255], v[254:255], v[62:63], v[46:47] op_sel:[0,0,0] op_sel_hi:[1,0,1]
    v_pk_fma_f32 v[254:255], v[30:31], v[62:63], v[254:255] op_sel:[0,1,0] op_sel_hi:[1,1,1] neg_lo:[0,1,0] neg_hi:[0,1,0]
    v_cvt_pk_bf16_f32 v191, v254, v255
    v_pk_max_i16 v191, v191, 0
    s_mov_b32 s60, 45056
    buffer_load_dwordx4 a[188:191], v7, s[48:51], s60 offen offset:3072
    buffer_store_dwordx4 v[184:187], v7, s[28:31], s37 offen sc1
    buffer_store_dwordx4 v[188:191], v7, s[28:31], s37 offen offset:1024 sc1
    s_mov_b32 s60, 49152
    buffer_load_dwordx4 a[192:195], v7, s[48:51], s60 offen offset:0
    s_mov_b32 s60, 49152
    buffer_load_dwordx4 a[196:199], v7, s[48:51], s60 offen offset:1024
    s_mov_b32 s60, 49152
    buffer_load_dwordx4 a[200:203], v7, s[48:51], s60 offen offset:2048
    s_mov_b32 s60, 49152
    buffer_load_dwordx4 a[204:207], v7, s[48:51], s60 offen offset:3072
    s_mov_b32 s60, 53248
    buffer_load_dwordx4 a[208:211], v7, s[48:51], s60 offen offset:0
    s_mov_b32 s60, 53248
    buffer_load_dwordx4 a[212:215], v7, s[48:51], s60 offen offset:1024
    s_mov_b32 s60, 53248
    buffer_load_dwordx4 a[216:219], v7, s[48:51], s60 offen offset:2048
    s_mov_b32 s60, 53248
    buffer_load_dwordx4 a[220:223], v7, s[48:51], s60 offen offset:3072
    s_waitcnt vmcnt(20)
    s_waitcnt vmcnt(8)
    s_barrier
    s_cmp_lg_u32 s10, 0
    s_cbranch_scc1 k34_noflag_10
    s_mul_i32 s3, s13, 14
    s_add_u32 s3, s3, s14
    s_add_u32 s3, s3, 256
    s_lshl_b32 s3, s3, 7
    v_mov_b32 v3, 0
    v_mov_b32 v4, 1
    s_mov_b64 exec, 1
    buffer_store_dword v4, v3, s[52:55], s3 offen sc1
    s_mov_b64 exec, -1
k34_noflag_10:
    s_mov_b32 s39, 1
    s_branch k34_phaseB
k34_stats:
    s_lshl_b32 s44, s6, 3
    s_and_b32 s45, s11, 1
    s_lshl_b32 s45, s45, 2
    s_add_u32 s44, s44, s45
    s_and_b32 s45, s12, 3
    s_add_u32 s44, s44, s45
    s_lshr_b32 s45, s12, 2
    s_mul_i32 s3, s45, 229376
    s_mul_i32 s7, s10, 57344
    s_add_u32 s3, s3, s7
    s_and_b32 s7, s11, 0
    s_cmp_eq_u32 s7, 0
    s_cbranch_scc1 k34_rep0_11
    s_sub_u32 s7, s7, 1
    s_lshl_b32 s7, s7, 21
    s_add_u32 s3, s3, s7
    s_add_u32 s3, s3, 11534336
k34_rep0_11:
    s_add_u32 s48, s8, 9437184
    s_addc_u32 s49, s9, 0
    s_add_u32 s48, s48, s3
    s_addc_u32 s49, s49, 0
    s_mov_b32 s50, 57344
    s_mov_b32 s51, 0x20000
    s_add_u32 s52, s8, 6815744
    s_addc_u32 s53, s9, 0
    s_mov_b32 s54, 65536
    s_mov_b32 s55, 0x20000
    s_add_u32 s56, s8, 6946816
    s_addc_u32 s57, s9, 0
    s_mov_b32 s58, 16384
    s_mov_b32 s59, 0x20000
    s_mul_i32 s3, s10, 14
    s_lshr_b32 s3, s3, 2
    s_lshr_b32 s7, s44, 1
    s_mul_i32 s7, s7, 14
    s_add_u32 s3, s3, s7
    s_lshl_b32 s47, s3, 7
    v_and_b32 v53, 3, v2
    v_lshlrev_b32 v53, 7, v53
    s_lshr_b32 s3, s44, 1
    s_lshl_b32 s3, s3, 2
    s_and_b32 s7, s44, 1
    s_add_u32 s46, s3, s7
    s_mul_i32 s3, s46, 114688
    s_mul_i32 s7, s10, 28672
    s_add_u32 s3, s3, s7
    s_add_u32 s40, s8, 11534336
    s_addc_u32 s41, s9, 0
    s_add_u32 s40, s40, s3
    s_addc_u32 s41, s41, 0
    s_mov_b32 s42, 258048
    s_mov_b32 s43, 0x20000
    s_and_b32 s3, s11, 1
    s_lshl_b32 s3, s3, 2
    s_add_u32 s3, s3, s12
    s_sub_u32 s3, s3, 28
    s_lshl_b32 s7, s6, 3
    s_add_u32 s62, s7, s3
    v_lshrrev_b32 v3, 3, v2
    v_and_b32 v4, 7, v2
    v_lshlrev_b32 v5, 12, v3
    v_lshl_add_u32 v5, v4, 4, v5
    s_lshl_b32 s3, s62, 7
    v_add_u32 v5, s3, v5
    s_lshl_b32 s34, s10, 19
    buffer_load_dwordx4 v[64:67], v5, s[16:19], s34 offen
    s_add_u32 s34, s34, 32768
    buffer_load_dwordx4 v[68:71], v5, s[16:19], s34 offen
    s_add_u32 s34, s34, 32768
    buffer_load_dwordx4 v[72:75], v5, s[16:19], s34 offen
    s_add_u32 s34, s34, 32768
    buffer_load_dwordx4 v[76:79], v5, s[16:19], s34 offen
    s_add_u32 s34, s34, 32768
    buffer_load_dwordx4 v[80:83], v5, s[16:19], s34 offen
    s_add_u32 s34, s34, 32768
    buffer_load_dwordx4 v[84:87], v5, s[16:19], s34 offen
    s_add_u32 s34, s34, 32768
    buffer_load_dwordx4 v[88:91], v5, s[16:19], s34 offen
    s_add_u32 s34, s34, 32768
    buffer_load_dwordx4 v[92:95], v5, s[16:19], s34 offen
    s_add_u32 s34, s34, 32768
    buffer_load_dwordx4 v[96:99], v5, s[16:19], s34 offen
    s_add_u32 s34, s34, 32768
    buffer_load_dwordx4 v[100:103], v5, s[16:19], s34 offen
    s_add_u32 s34, s34, 32768
    buffer_load_dwordx4 v[104:107], v5, s[16:19], s34 offen
    s_add_u32 s34, s34, 32768
    buffer_load_dwordx4 v[108:111], v5, s[16:19], s34 offen
    s_add_u32 s34, s34, 32768
    buffer_load_dwordx4 v[112:115], v5, s[16:19], s34 offen
    s_add_u32 s34, s34, 32768
    buffer_load_dwordx4 v[116:119], v5, s[16:19], s34 offen
    s_add_u32 s34, s34, 32768
    buffer_load_dwordx4 v[120:123], v5, s[16:19], s34 offen
    s_add_u32 s34, s34, 32768
    buffer_load_dwordx4 v[124:127], v5, s[16:19], s34 offen
    v_mov_b32 v16, 0
    v_mov_b32 v17, 0
    v_mov_b32 v18, 0
    v_mov_b32 v19, 0
    v_mov_b32 v20, 0
    v_mov_b32 v21, 0
    v_mov_b32 v22, 0
    v_mov_b32 v23, 0
    v_mov_b32 v24, 0
    v_mov_b32 v25, 0
    v_mov_b32 v26, 0
    v_mov_b32 v27, 0
    v_mov_b32 v28, 0
    v_mov_b32 v29, 0
    v_mov_b32 v30, 0
    v_mov_b32 v31, 0
    s_waitcnt vmcnt(15)
    v_lshlrev_b32 v40, 16, v64
    v_and_b32 v41, 0xffff0000, v64
    v_lshlrev_b32 v42, 16, v65
    v_and_b32 v43, 0xffff0000, v65
    v_lshlrev_b32 v44, 16, v66
    v_and_b32 v45, 0xffff0000, v66
    v_lshlrev_b32 v46, 16, v67
    v_and_b32 v47, 0xffff0000, v67
    v_pk_add_f32 v[16:17], v[16:17], v[40:41]
    v_pk_fma_f32 v[24:25], v[40:41], v[40:41], v[24:25]
    v_pk_add_f32 v[18:19], v[18:19], v[42:43]
    v_pk_fma_f32 v[26:27], v[42:43], v[42:43], v[26:27]
    v_pk_add_f32 v[20:21], v[20:21], v[44:45]
    v_pk_fma_f32 v[28:29], v[44:45], v[44:45], v[28:29]
    v_pk_add_f32 v[22:23], v[22:23], v[46:47]
    v_pk_fma_f32 v[30:31], v[46:47], v[46:47], v[30:31]
    s_waitcnt vmcnt(14)
    v_lshlrev_b32 v40, 16, v68
    v_and_b32 v41, 0xffff0000, v68
    v_lshlrev_b32 v42, 16, v69
    v_and_b32 v43, 0xffff0000, v69
    v_lshlrev_b32 v44, 16, v70
    v_and_b32 v45, 0xffff0000, v70
    v_lshlrev_b32 v46, 16, v71
    v_and_b32 v47, 0xffff0000, v71
    v_pk_add_f32 v[16:17], v[16:17], v[40:41]
    v_pk_fma_f32 v[24:25], v[40:41], v[40:41], v[24:25]
    v_pk_add_f32 v[18:19], v[18:19], v[42:43]
    v_pk_fma_f32 v[26:27], v[42:43], v[42:43], v[26:27]
    v_pk_add_f32 v[20:21], v[20:21], v[44:45]
    v_pk_fma_f32 v[28:29], v[44:45], v[44:45], v[28:29]
    v_pk_add_f32 v[22:23], v[22:23], v[46:47]
    v_pk_fma_f32 v[30:31], v[46:47], v[46:47], v[30:31]
    s_waitcnt vmcnt(13)
    v_lshlrev_b32 v40, 16, v72
    v_and_b32 v41, 0xffff0000, v72
    v_lshlrev_b32 v42, 16, v73
    v_and_b32 v43, 0xffff0000, v73
    v_lshlrev_b32 v44, 16, v74
    v_and_b32 v45, 0xffff0000, v74
    v_lshlrev_b32 v46, 16, v75
    v_and_b32 v47, 0xffff0000, v75
    v_pk_add_f32 v[16:17], v[16:17], v[40:41]
    v_pk_fma_f32 v[24:25], v[40:41], v[40:41], v[24:25]
    v_pk_add_f32 v[18:19], v[18:19], v[42:43]
    v_pk_fma_f32 v[26:27], v[42:43], v[42:43], v[26:27]
    v_pk_add_f32 v[20:21], v[20:21], v[44:45]
    v_pk_fma_f32 v[28:29], v[44:45], v[44:45], v[28:29]
    v_pk_add_f32 v[22:23], v[22:23], v[46:47]
    v_pk_fma_f32 v[30:31], v[46:47], v[46:47], v[30:31]
    s_waitcnt vmcnt(12)
    v_lshlrev_b32 v40, 16, v76
    v_and_b32 v41, 0xffff0000, v76
    v_lshlrev_b32 v42, 16, v77
    v_and_b32 v43, 0xffff0000, v77
    v_lshlrev_b32 v44, 16, v78
    v_and_b32 v45, 0xffff0000, v78
    v_lshlrev_b32 v46, 16, v79
    v_and_b32 v47, 0xffff0000, v79
    v_pk_add_f32 v[16:17], v[16:17], v[40:41]
    v_pk_fma_f32 v[24:25], v[40:41], v[40:41], v[24:25]
    v_pk_add_f32 v[18:19], v[18:19], v[42:43]
    v_pk_fma_f32 v[26:27], v[42:43], v[42:43], v[26:27]
    v_pk_add_f32 v[20:21], v[20:21], v[44:45]
    v_pk_fma_f32 v[28:29], v[44:45], v[44:45], v[28:29]
    v_pk_add_f32 v[22:23], v[22:23], v[46:47]
    v_pk_fma_f32 v[30:31], v[46:47], v[46:47], v[30:31]
    s_waitcnt vmcnt(11)
    v_lshlrev_b32 v40, 16, v80
    v_and_b32 v41, 0xffff0000, v80
    v_lshlrev_b32 v42, 16, v81
    v_and_b32 v43, 0xffff0000, v81
    v_lshlrev_b32 v44, 16, v82
    v_and_b32 v45, 0xffff0000, v82
    v_lshlrev_b32 v46, 16, v83
    v_and_b32 v47, 0xffff0000, v83
    v_pk_add_f32 v[16:17], v[16:17], v[40:41]
    v_pk_fma_f32 v[24:25], v[40:41], v[40:41], v[24:25]
    v_pk_add_f32 v[18:19], v[18:19], v[42:43]
    v_pk_fma_f32 v[26:27], v[42:43], v[42:43], v[26:27]
    v_pk_add_f32 v[20:21], v[20:21], v[44:45]
    v_pk_fma_f32 v[28:29], v[44:45], v[44:45], v[28:29]
    v_pk_add_f32 v[22:23], v[22:23], v[46:47]
    v_pk_fma_f32 v[30:31], v[46:47], v[46:47], v[30:31]
    s_waitcnt vmcnt(10)
    v_lshlrev_b32 v40, 16, v84
    v_and_b32 v41, 0xffff0000, v84
    v_lshlrev_b32 v42, 16, v85
    v_and_b32 v43, 0xffff0000, v85
    v_lshlrev_b32 v44, 16, v86
    v_and_b32 v45, 0xffff0000, v86
    v_lshlrev_b32 v46, 16, v87
    v_and_b32 v47, 0xffff0000, v87
    v_pk_add_f32 v[16:17], v[16:17], v[40:41]
    v_pk_fma_f32 v[24:25], v[40:41], v[40:41], v[24:25]
    v_pk_add_f32 v[18:19], v[18:19], v[42:43]
    v_pk_fma_f32 v[26:27], v[42:43], v[42:43], v[26:27]
    v_pk_add_f32 v[20:21], v[20:21], v[44:45]
    v_pk_fma_f32 v[28:29], v[44:45], v[44:45], v[28:29]
    v_pk_add_f32 v[22:23], v[22:23], v[46:47]
    v_pk_fma_f32 v[30:31], v[46:47], v[46:47], v[30:31]
    s_waitcnt vmcnt(9)
    v_lshlrev_b32 v40, 16, v88
    v_and_b32 v41, 0xffff0000, v88
    v_lshlrev_b32 v42, 16, v89
    v_and_b32 v43, 0xffff0000, v89
    v_lshlrev_b32 v44, 16, v90
    v_and_b32 v45, 0xffff0000, v90
    v_lshlrev_b32 v46, 16, v91
    v_and_b32 v47, 0xffff0000, v91
    v_pk_add_f32 v[16:17], v[16:17], v[40:41]
    v_pk_fma_f32 v[24:25], v[40:41], v[40:41], v[24:25]
    v_pk_add_f32 v[18:19], v[18:19], v[42:43]
    v_pk_fma_f32 v[26:27], v[42:43], v[42:43], v[26:27]
    v_pk_add_f32 v[20:21], v[20:21], v[44:45]
    v_pk_fma_f32 v[28:29], v[44:45], v[44:45], v[28:29]
    v_pk_add_f32 v[22:23], v[22:23], v[46:47]
    v_pk_fma_f32 v[30:31], v[46:47], v[46:47], v[30:31]
    s_waitcnt vmcnt(8)
    v_lshlrev_b32 v40, 16, v92
    v_and_b32 v41, 0xffff0000, v92
    v_lshlrev_b32 v42, 16, v93
    v_and_b32 v43, 0xffff0000, v93
    v_lshlrev_b32 v44, 16, v94
    v_and_b32 v45, 0xffff0000, v94
    v_lshlrev_b32 v46, 16, v95
    v_and_b32 v47, 0xffff0000, v95
    v_pk_add_f32 v[16:17], v[16:17], v[40:41]
    v_pk_fma_f32 v[24:25], v[40:41], v[40:41], v[24:25]
    v_pk_add_f32 v[18:19], v[18:19], v[42:43]
    v_pk_fma_f32 v[26:27], v[42:43], v[42:43], v[26:27]
    v_pk_add_f32 v[20:21], v[20:21], v[44:45]
    v_pk_fma_f32 v[28:29], v[44:45], v[44:45], v[28:29]
    v_pk_add_f32 v[22:23], v[22:23], v[46:47]
    v_pk_fma_f32 v[30:31], v[46:47], v[46:47], v[30:31]
    s_waitcnt vmcnt(7)
    v_lshlrev_b32 v40, 16, v96
    v_and_b32 v41, 0xffff0000, v96
    v_lshlrev_b32 v42, 16, v97
    v_and_b32 v43, 0xffff0000, v97
    v_lshlrev_b32 v44, 16, v98
    v_and_b32 v45, 0xffff0000, v98
    v_lshlrev_b32 v46, 16, v99
    v_and_b32 v47, 0xffff0000, v99
    v_pk_add_f32 v[16:17], v[16:17], v[40:41]
    v_pk_fma_f32 v[24:25], v[40:41], v[40:41], v[24:25]
    v_pk_add_f32 v[18:19], v[18:19], v[42:43]
    v_pk_fma_f32 v[26:27], v[42:43], v[42:43], v[26:27]
    v_pk_add_f32 v[20:21], v[20:21], v[44:45]
    v_pk_fma_f32 v[28:29], v[44:45], v[44:45], v[28:29]
    v_pk_add_f32 v[22:23], v[22:23], v[46:47]
    v_pk_fma_f32 v[30:31], v[46:47], v[46:47], v[30:31]
    s_waitcnt vmcnt(6)
    v_lshlrev_b32 v40, 16, v100
    v_and_b32 v41, 0xffff0000, v100
    v_lshlrev_b32 v42, 16, v101
    v_and_b32 v43, 0xffff0000, v101
    v_lshlrev_b32 v44, 16, v102
    v_and_b32 v45, 0xffff0000, v102
    v_lshlrev_b32 v46, 16, v103
    v_and_b32 v47, 0xffff0000, v103
    v_pk_add_f32 v[16:17], v[16:17], v[40:41]
    v_pk_fma_f32 v[24:25], v[40:41], v[40:41], v[24:25]
    v_pk_add_f32 v[18:19], v[18:19], v[42:43]
    v_pk_fma_f32 v[26:27], v[42:43], v[42:43], v[26:27]
    v_pk_add_f32 v[20:21], v[20:21], v[44:45]
    v_pk_fma_f32 v[28:29], v[44:45], v[44:45], v[28:29]
    v_pk_add_f32 v[22:23], v[22:23], v[46:47]
    v_pk_fma_f32 v[30:31], v[46:47], v[46:47], v[30:31]
    s_waitcnt vmcnt(5)
    v_lshlrev_b32 v40, 16, v104
    v_and_b32 v41, 0xffff0000, v104
    v_lshlrev_b32 v42, 16, v105
    v_and_b32 v43, 0xffff0000, v105
    v_lshlrev_b32 v44, 16, v106
    v_and_b32 v45, 0xffff0000, v106
    v_lshlrev_b32 v46, 16, v107
    v_and_b32 v47, 0xffff0000, v107
    v_pk_add_f32 v[16:17], v[16:17], v[40:41]
    v_pk_fma_f32 v[24:25], v[40:41], v[40:41], v[24:25]
    v_pk_add_f32 v[18:19], v[18:19], v[42:43]
    v_pk_fma_f32 v[26:27], v[42:43], v[42:43], v[26:27]
    v_pk_add_f32 v[20:21], v[20:21], v[44:45]
    v_pk_fma_f32 v[28:29], v[44:45], v[44:45], v[28:29]
    v_pk_add_f32 v[22:23], v[22:23], v[46:47]
    v_pk_fma_f32 v[30:31], v[46:47], v[46:47], v[30:31]
    s_waitcnt vmcnt(4)
    v_lshlrev_b32 v40, 16, v108
    v_and_b32 v41, 0xffff0000, v108
    v_lshlrev_b32 v42, 16, v109
    v_and_b32 v43, 0xffff0000, v109
    v_lshlrev_b32 v44, 16, v110
    v_and_b32 v45, 0xffff0000, v110
    v_lshlrev_b32 v46, 16, v111
    v_and_b32 v47, 0xffff0000, v111
    v_pk_add_f32 v[16:17], v[16:17], v[40:41]
    v_pk_fma_f32 v[24:25], v[40:41], v[40:41], v[24:25]
    v_pk_add_f32 v[18:19], v[18:19], v[42:43]
    v_pk_fma_f32 v[26:27], v[42:43], v[42:43], v[26:27]
    v_pk_add_f32 v[20:21], v[20:21], v[44:45]
    v_pk_fma_f32 v[28:29], v[44:45], v[44:45], v[28:29]
    v_pk_add_f32 v[22:23], v[22:23], v[46:47]
    v_pk_fma_f32 v[30:31], v[46:47], v[46:47], v[30:31]
    s_waitcnt vmcnt(3)
    v_lshlrev_b32 v40, 16, v112
    v_and_b32 v41, 0xffff0000, v112
    v_lshlrev_b32 v42, 16, v113
    v_and_b32 v43, 0xffff0000, v113
    v_lshlrev_b32 v44, 16, v114
    v_and_b32 v45, 0xffff0000, v114
    v_lshlrev_b32 v46, 16, v115
    v_and_b32 v47, 0xffff0000, v115
    v_pk_add_f32 v[16:17], v[16:17], v[40:41]
    v_pk_fma_f32 v[24:25], v[40:41], v[40:41], v[24:25]
    v_pk_add_f32 v[18:19], v[18:19], v[42:43]
    v_pk_fma_f32 v[26:27], v[42:43], v[42:43], v[26:27]
    v_pk_add_f32 v[20:21], v[20:21], v[44:45]
    v_pk_fma_f32 v[28:29], v[44:45], v[44:45], v[28:29]
    v_pk_add_f32 v[22:23], v[22:23], v[46:47]
    v_pk_fma_f32 v[30:31], v[46:47], v[46:47], v[30:31]
    s_waitcnt vmcnt(2)
    v_lshlrev_b32 v40, 16, v116
    v_and_b32 v41, 0xffff0000, v116
    v_lshlrev_b32 v42, 16, v117
    v_and_b32 v43, 0xffff0000, v117
    v_lshlrev_b32 v44, 16, v118
    v_and_b32 v45, 0xffff0000, v118
    v_lshlrev_b32 v46, 16, v119
    v_and_b32 v47, 0xffff0000, v119
    v_pk_add_f32 v[16:17], v[16:17], v[40:41]
    v_pk_fma_f32 v[24:25], v[40:41], v[40:41], v[24:25]
    v_pk_add_f32 v[18:19], v[18:19], v[42:43]
    v_pk_fma_f32 v[26:27], v[42:43], v[42:43], v[26:27]
    v_pk_add_f32 v[20:21], v[20:21], v[44:45]
    v_pk_fma_f32 v[28:29], v[44:45], v[44:45], v[28:29]
    v_pk_add_f32 v[22:23], v[22:23], v[46:47]
    v_pk_fma_f32 v[30:31], v[46:47], v[46:47], v[30:31]
    s_waitcnt vmcnt(1)
    v_lshlrev_b32 v40, 16, v120
    v_and_b32 v41, 0xffff0000, v120
    v_lshlrev_b32 v42, 16, v121
    v_and_b32 v43, 0xffff0000, v121
    v_lshlrev_b32 v44, 16, v122
    v_and_b32 v45, 0xffff0000, v122
    v_lshlrev_b32 v46, 16, v123
    v_and_b32 v47, 0xffff0000, v123
    v_pk_add_f32 v[16:17], v[16:17], v[40:41]
    v_pk_fma_f32 v[24:25], v[40:41], v[40:41], v[24:25]
    v_pk_add_f32 v[18:19], v[18:19], v[42:43]
    v_pk_fma_f32 v[26:27], v[42:43], v[42:43], v[26:27]
    v_pk_add_f32 v[20:21], v[20:21], v[44:45]
    v_pk_fma_f32 v[28:29], v[44:45], v[44:45], v[28:29]
    v_pk_add_f32 v[22:23], v[22:23], v[46:47]
    v_pk_fma_f32 v[30:31], v[46:47], v[46:47], v[30:31]
    s_waitcnt vmcnt(0)
    v_lshlrev_b32 v40, 16, v124
    v_and_b32 v41, 0xffff0000, v124
    v_lshlrev_b32 v42, 16, v125
    v_and_b32 v43, 0xffff0000, v125
    v_lshlrev_b32 v44, 16, v126
    v_and_b32 v45, 0xffff0000, v126
    v_lshlrev_b32 v46, 16, v127
    v_and_b32 v47, 0xffff0000, v127
    v_pk_add_f32 v[16:17], v[16:17], v[40:41]
    v_pk_fma_f32 v[24:25], v[40:41], v[40:41], v[24:25]
    v_pk_add_f32 v[18:19], v[18:19], v[42:43]
    v_pk_fma_f32 v[26:27], v[42:43], v[42:43], v[26:27]
    v_pk_add_f32 v[20:21], v[20:21], v[44:45]
    v_pk_fma_f32 v[28:29], v[44:45], v[44:45], v[28:29]
    v_pk_add_f32 v[22:23], v[22:23], v[46:47]
    v_pk_fma_f32 v[30:31], v[46:47], v[46:47], v[30:31]
    s_lshl_b32 s3, s10, 12
    v_lshlrev_b32 v5, 9, v3
    v_lshl_add_u32 v5, v4, 5, v5
    v_add_u32 v5, s3, v5
    ds_write_b128 v5, v[16:19]
    ds_write_b128 v5, v[20:23] offset:16
    ds_write_b128 v5, v[24:27] offset:256
    ds_write_b128 v5, v[28:31] offset:272
    s_waitcnt lgkmcnt(0)
    s_barrier
    s_cmp_ge_u32 s10, 2
    s_cbranch_scc1 k34_stats_wait
    s_lshl_b32 s3, s10, 8
    v_lshlrev_b32 v5, 2, v2
    v_add_u32 v5, s3, v5
    ds_read_b32 v64, v5 offset:0
    ds_read_b32 v65, v5 offset:512
    ds_read_b32 v66, v5 offset:1024
    ds_read_b32 v67, v5 offset:1536
    ds_read_b32 v68, v5 offset:2048
    ds_read_b32 v69, v5 offset:2560
    ds_read_b32 v70, v5 offset:3072
    ds_read_b32 v71, v5 offset:3584
    ds_read_b32 v72, v5 offset:4096
    ds_read_b32 v73, v5 offset:4608
    ds_read_b32 v74, v5 offset:5120
    ds_read_b32 v75, v5 offset:5632
    ds_read_b32 v76, v5 offset:6144
    ds_read_b32 v77, v5 offset:6656
    ds_read_b32 v78, v5 offset:7168
    ds_read_b32 v79, v5 offset:7680
    ds_read_b32 v80, v5 offset:8192
    ds_read_b32 v81, v5 offset:8704
    ds_read_b32 v82, v5 offset:9216
    ds_read_b32 v83, v5 offset:9728
    ds_read_b32 v84, v5 offset:10240
    ds_read_b32 v85, v5 offset:10752
    ds_read_b32 v86, v5 offset:11264
    ds_read_b32 v87, v5 offset:11776
    ds_read_b32 v88, v5 offset:12288
    ds_read_b32 v89, v5 offset:12800
    ds_read_b32 v90, v5 offset:13312
    ds_read_b32 v91, v5 offset:13824
    ds_read_b32 v92, v5 offset:14336
    ds_read_b32 v93, v5 offset:14848
    ds_read_b32 v94, v5 offset:15360
    ds_read_b32 v95, v5 offset:15872
    s_waitcnt lgkmcnt(0)
    v_add_f32 v64, v64, v80
    v_add_f32 v65, v65, v81
    v_add_f32 v66, v66, v82
    v_add_f32 v67, v67, v83
    v_add_f32 v68, v68, v84
    v_add_f32 v69, v69, v85
    v_add_f32 v70, v70, v86
    v_add_f32 v71, v71, v87
    v_add_f32 v72, v72, v88
    v_add_f32 v73, v73, v89
    v_add_f32 v74, v74, v90
    v_add_f32 v75, v75, v91
    v_add_f32 v76, v76, v92
    v_add_f32 v77, v77, v93
    v_add_f32 v78, v78, v94
    v_add_f32 v79, v79, v95
    v_add_f32 v64, v64, v72
    v_add_f32 v65, v65, v73
    v_add_f32 v66, v66, v74
    v_add_f32 v67, v67, v75
    v_add_f32 v68, v68, v76
    v_add_f32 v69, v69, v77
    v_add_f32 v70, v70, v78
    v_add_f32 v71, v71, v79
    v_add_f32 v64, v64, v68
    v_add_f32 v65, v65, v69
    v_add_f32 v66, v66, v70
    v_add_f32 v67, v67, v71
    v_add_f32 v64, v64, v66
    v_add_f32 v65, v65, v67
    v_add_f32 v64, v64, v65
    v_lshlrev_b32 v5, 2, v2
    s_cmp_eq_u32 s10, 0
    s_cbranch_scc1 k34_stats_w0
    ds_write_b32 v5, v64 offset:16384
    s_waitcnt lgkmcnt(0)
k34_stats_w0:
k34_stats_wait:
    s_barrier
    s_cmp_lg_u32 s10, 0
    s_cbranch_scc1 k34_stats_end
    ds_read_b32 v65, v5 offset:16384
    s_waitcnt lgkmcnt(0)
    v_mul_f32 v64, 0x3b000000, v64
    v_mul_f32 v65, 0x3b000000, v65
    v_fma_f32 v65, -v64, v64, v65
    v_max_f32 v65, 0, v65
    v_add_f32 v65, 0x3727c5ac, v65
    v_rsq_f32 v66, v65
    s_nop 0
    v_mul_f32 v67, v64, v66
    v_lshlrev_b32 v5, 3, v2
    s_lshl_b32 s3, s62, 9
    buffer_store_dwordx2 v[66:67], v5, s[56:59], s3 offen sc1
k34_stats_end:
    s_mov_b32 s60, 0
    buffer_load_dwordx4 a[0:3], v7, s[48:51], s60 offen offset:0
    s_mov_b32 s60, 0
    buffer_load_dwordx4 a[4:7], v7, s[48:51], s60 offen offset:1024
    s_mov_b32 s60, 0
    buffer_load_dwordx4 a[8:11], v7, s[48:51], s60 offen offset:2048
    s_mov_b32 s60, 0
    buffer_load_dwordx4 a[12:15], v7, s[48:51], s60 offen offset:3072
    s_mov_b32 s60, 4096
    buffer_load_dwordx4 a[16:19], v7, s[48:51], s60 offen offset:0
    s_mov_b32 s60, 4096
    buffer_load_dwordx4 a[20:23], v7, s[48:51], s60 offen offset:1024
    s_mov_b32 s60, 4096
    buffer_load_dwordx4 a[24:27], v7, s[48:51], s60 offen offset:2048
    s_mov_b32 s60, 4096
    buffer_load_dwordx4 a[28:31], v7, s[48:51], s60 offen offset:3072
    s_mov_b32 s60, 8192
    buffer_load_dwordx4 a[32:35], v7, s[48:51], s60 offen offset:0
    s_mov_b32 s60, 8192
    buffer_load_dwordx4 a[36:39], v7, s[48:51], s60 offen offset:1024
    s_mov_b32 s60, 8192
    buffer_load_dwordx4 a[40:43], v7, s[48:51], s60 offen offset:2048
    s_mov_b32 s60, 8192
    buffer_load_dwordx4 a[44:47], v7, s[48:51], s60 offen offset:3072
    s_mov_b32 s60, 12288
    buffer_load_dwordx4 a[48:51], v7, s[48:51], s60 offen offset:0
    s_mov_b32 s60, 12288
    buffer_load_dwordx4 a[52:55], v7, s[48:51], s60 offen offset:1024
    s_mov_b32 s60, 12288
    buffer_load_dwordx4 a[56:59], v7, s[48:51], s60 offen offset:2048
    s_mov_b32 s60, 12288
    buffer_load_dwordx4 a[60:63], v7, s[48:51], s60 offen offset:3072
    s_mov_b32 s60, 16384
    buffer_load_dwordx4 a[64:67], v7, s[48:51], s60 offen offset:0
    s_mov_b32 s60, 16384
    buffer_load_dwordx4 a[68:71], v7, s[48:51], s60 offen offset:1024
    s_mov_b32 s60, 16384
    buffer_load_dwordx4 a[72:75], v7, s[48:51], s60 offen offset:2048
    s_mov_b32 s60, 16384
    buffer_load_dwordx4 a[76:79], v7, s[48:51], s60 offen offset:3072
    s_mov_b32 s60, 20480
    buffer_load_dwordx4 a[80:83], v7, s[48:51], s60 offen offset:0
    s_mov_b32 s60, 20480
    buffer_load_dwordx4 a[84:87], v7, s[48:51], s60 offen offset:1024
    s_mov_b32 s60, 20480
    buffer_load_dwordx4 a[88:91], v7, s[48:51], s60 offen offset:2048
    s_mov_b32 s60, 20480
    buffer_load_dwordx4 a[92:95], v7, s[48:51], s60 offen offset:3072
    s_mov_b32 s60, 24576
    buffer_load_dwordx4 a[96:99], v7, s[48:51], s60 offen offset:0
    s_mov_b32 s60, 24576
    buffer_load_dwordx4 a[100:103], v7, s[48:51], s60 offen offset:1024
    s_mov_b32 s60, 24576
    buffer_load_dwordx4 a[104:107], v7, s[48:51], s60 offen offset:2048
    s_mov_b32 s60, 24576
    buffer_load_dwordx4 a[108:111], v7, s[48:51], s60 offen offset:3072
    s_mov_b32 s60, 28672
    buffer_load_dwordx4 a[112:115], v7, s[48:51], s60 offen offset:0
    s_mov_b32 s60, 28672
    buffer_load_dwordx4 a[116:119], v7, s[48:51], s60 offen offset:1024
    s_mov_b32 s60, 28672
    buffer_load_dwordx4 a[120:123], v7, s[48:51], s60 offen offset:2048
    s_mov_b32 s60, 28672
    buffer_load_dwordx4 a[124:127], v7, s[48:51], s60 offen offset:3072
    s_mov_b32 s60, 32768
    buffer_load_dwordx4 a[128:131], v7, s[48:51], s60 offen offset:0
    s_mov_b32 s60, 32768
    buffer_load_dwordx4 a[132:135], v7, s[48:51], s60 offen offset:1024
    s_mov_b32 s60, 32768
    buffer_load_dwordx4 a[136:139], v7, s[48:51], s60 offen offset:2048
    s_mov_b32 s60, 32768
    buffer_load_dwordx4 a[140:143], v7, s[48:51], s60 offen offset:3072
    s_mov_b32 s60, 36864
    buffer_load_dwordx4 a[144:147], v7, s[48:51], s60 offen offset:0
    s_mov_b32 s60, 36864
    buffer_load_dwordx4 a[148:151], v7, s[48:51], s60 offen offset:1024
    s_mov_b32 s60, 36864
    buffer_load_dwordx4 a[152:155], v7, s[48:51], s60 offen offset:2048
    s_mov_b32 s60, 36864
    buffer_load_dwordx4 a[156:159], v7, s[48:51], s60 offen offset:3072
    s_mov_b32 s60, 40960
    buffer_load_dwordx4 a[160:163], v7, s[48:51], s60 offen offset:0
    s_mov_b32 s60, 40960
    buffer_load_dwordx4 a[164:167], v7, s[48:51], s60 offen offset:1024
    s_mov_b32 s60, 40960
    buffer_load_dwordx4 a[168:171], v7, s[48:51], s60 offen offset:2048
    s_mov_b32 s60, 40960
    buffer_load_dwordx4 a[172:175], v7, s[48:51], s60 offen offset:3072
    s_mov_b32 s60, 45056
    buffer_load_dwordx4 a[176:179], v7, s[48:51], s60 offen offset:0
    s_mov_b32 s60, 45056
    buffer_load_dwordx4 a[180:183], v7, s[48:51], s60 offen offset:1024
    s_mov_b32 s60, 45056
    buffer_load_dwordx4 a[184:187], v7, s[48:51], s60 offen offset:2048
    s_mov_b32 s60, 45056
    buffer_load_dwordx4 a[188:191], v7, s[48:51], s60 offen offset:3072
    s_mov_b32 s60, 49152
    buffer_load_dwordx4 a[192:195], v7, s[48:51], s60 offen offset:0
    s_mov_b32 s60, 49152
    buffer_load_dwordx4 a[196:199], v7, s[48:51], s60 offen offset:1024
    s_mov_b32 s60, 49152
    buffer_load_dwordx4 a[200:203], v7, s[48:51], s60 offen offset:2048
    s_mov_b32 s60, 49152
    buffer_load_dwordx4 a[204:207], v7, s[48:51], s60 offen offset:3072
    s_mov_b32 s60, 53248
    buffer_load_dwordx4 a[208:211], v7, s[48:51], s60 offen offset:0
    s_mov_b32 s60, 53248
    buffer_load_dwordx4 a[212:215], v7, s[48:51], s60 offen offset:1024
    s_mov_b32 s60, 53248
    buffer_load_dwordx4 a[216:219], v7, s[48:51], s60 offen offset:2048
    s_mov_b32 s60, 53248
    buffer_load_dwordx4 a[220:223], v7, s[48:51], s60 offen offset:3072
    s_barrier
    s_mov_b32 s39, 0
    v_mov_b32 v50, 0
k34_phaseB:
    v_cmp_ne_u32 vcc, 1, v50
    s_cbranch_vccz k34_poll0_done
    s_add_u32 s3, s47, 0
    s_mov_b32 s61, 0
k34_poll0:
    buffer_load_dword v50, v53, s[52:55], s3 offen sc1
    s_waitcnt vmcnt(0)
    v_cmp_ne_u32 vcc, 1, v50
    s_cbranch_vccz k34_poll0_done
    s_add_u32 s61, s61, 1
    s_cmp_lt_u32 s61, 100000
    s_cbranch_scc1 k34_poll0
k34_poll0_done:
    s_mov_b32 s36, 0
    buffer_load_dwordx4 v[64:67], v7, s[40:43], s36 offen offset:0 sc1
    s_mov_b32 s36, 0
    buffer_load_dwordx4 v[68:71], v7, s[40:43], s36 offen offset:1024 sc1
    s_mov_b32 s36, 0
    buffer_load_dwordx4 v[72:75], v7, s[40:43], s36 offen offset:2048 sc1
    s_mov_b32 s36, 0
    buffer_load_dwordx4 v[76:79], v7, s[40:43], s36 offen offset:3072 sc1
    s_mov_b32 s36, 4096
    buffer_load_dwordx4 v[80:83], v7, s[40:43], s36 offen offset:0 sc1
    s_mov_b32 s36, 4096
    buffer_load_dwordx4 v[84:87], v7, s[40:43], s36 offen offset:1024 sc1
    s_mov_b32 s36, 4096
    buffer_load_dwordx4 v[88:91], v7, s[40:43], s36 offen offset:2048 sc1
    s_mov_b32 s36, 4096
    buffer_load_dwordx4 v[92:95], v7, s[40:43], s36 offen offset:3072 sc1
    s_mov_b32 s36, 8192
    buffer_load_dwordx4 v[96:99], v7, s[40:43], s36 offen offset:0 sc1
    s_mov_b32 s36, 8192
    buffer_load_dwordx4 v[100:103], v7, s[40:43], s36 offen offset:1024 sc1
    s_mov_b32 s36, 8192
    buffer_load_dwordx4 v[104:107], v7, s[40:43], s36 offen offset:2048 sc1
    s_mov_b32 s36, 8192
    buffer_load_dwordx4 v[108:111], v7, s[40:43], s36 offen offset:3072 sc1
    s_mov_b32 s36, 12288
    buffer_load_dwordx4 v[112:115], v7, s[40:43], s36 offen offset:0 sc1
    s_mov_b32 s36, 12288
    buffer_load_dwordx4 v[116:119], v7, s[40:43], s36 offen offset:1024 sc1
    s_mov_b32 s36, 12288
    buffer_load_dwordx4 v[120:123], v7, s[40:43], s36 offen offset:2048 sc1
    s_mov_b32 s36, 12288
    buffer_load_dwordx4 v[124:127], v7, s[40:43], s36 offen offset:3072 sc1
    s_mov_b32 s36, 16384
    buffer_load_dwordx4 v[128:131], v7, s[40:43], s36 offen offset:0 sc1
    s_mov_b32 s36, 16384
    buffer_load_dwordx4 v[132:135], v7, s[40:43], s36 offen offset:1024 sc1
    s_mov_b32 s36, 16384
    buffer_load_dwordx4 v[136:139], v7, s[40:43], s36 offen offset:2048 sc1
    s_mov_b32 s36, 16384
    buffer_load_dwordx4 v[140:143], v7, s[40:43], s36 offen offset:3072 sc1
    s_mov_b32 s36, 20480
    buffer_load_dwordx4 v[144:147], v7, s[40:43], s36 offen offset:0 sc1
    s_mov_b32 s36, 20480
    buffer_load_dwordx4 v[148:151], v7, s[40:43], s36 offen offset:1024 sc1
    s_mov_b32 s36, 20480
    buffer_load_dwordx4 v[152:155], v7, s[40:43], s36 offen offset:2048 sc1
    s_mov_b32 s36, 20480
    buffer_load_dwordx4 v[156:159], v7, s[40:43], s36 offen offset:3072 sc1
    s_mov_b32 s36, 24576
    buffer_load_dwordx4 v[160:163], v7, s[40:43], s36 offen offset:0 sc1
    s_mov_b32 s36, 24576
    buffer_load_dwordx4 v[164:167], v7, s[40:43], s36 offen offset:1024 sc1
    s_mov_b32 s36, 24576
    buffer_load_dwordx4 v[168:171], v7, s[40:43], s36 offen offset:2048 sc1
    s_mov_b32 s36, 24576
    buffer_load_dwordx4 v[172:175], v7, s[40:43], s36 offen offset:3072 sc1
    s_add_u32 s24, s8, 4194304
    s_addc_u32 s25, s9, 0
    s_mov_b32 s26, 2097152
    s_mov_b32 s27, 0x20000
    s_mov_b32 s28, s4
    s_mov_b32 s29, s5
    s_mov_b32 s30, 2097152
    s_mov_b32 s31, 0x20000
    s_add_u32 s32, s8, 6356992
    s_addc_u32 s33, s9, 0
    s_mov_b32 s34, 12288
    s_mov_b32 s35, 0x20000
    s_waitcnt vmcnt(27)
    v_mfma_f32_32x32x16_bf16 v[192:207], a[0:3], v[64:67], 0
    v_mfma_f32_32x32x16_bf16 v[224:239], a[4:7], v[64:67], 0
    s_waitcnt vmcnt(26)
    v_mfma_f32_32x32x16_bf16 v[192:207], a[8:11], v[68:71], v[192:207]
    v_mfma_f32_32x32x16_bf16 v[224:239], a[12:15], v[68:71], v[224:239]
    v_lshrrev_b32 v3, 3, v2
    v_lshlrev_b32 v3, 12, v3
    v_and_b32 v4, 3, v2
    v_lshl_add_u32 v3, v4, 4, v3
    v_lshrrev_b32 v4, 2, v2
    v_and_b32 v4, 1, v4
    v_lshl_add_u32 v3, v4, 7, v3
    s_lshl_b32 s3, s46, 6
    v_add_u32 v3, s3, v3
    s_lshl_b32 s3, s45, 6
    s_lshl_b32 s7, s10, 4
    s_add_u32 s3, s3, s7
    s_lshl_b32 s3, s3, 12
    s_lshl_b32 s7, s10, 11
    s_mov_b32 m0, s7
    s_nop 0
    buffer_load_dwordx4 v3, s[24:27], s3 offen lds
    s_add_u32 s3, s3, 32768
    s_add_u32 m0, s7, 1024
    s_nop 0
    buffer_load_dwordx4 v3, s[24:27], s3 offen lds
    v_lshrrev_b32 v9, 4, v2
    s_lshr_b32 s3, s10, 1
    s_lshl_b32 s3, s3, 2
    v_add_u32 v9, s3, v9
    v_lshlrev_b32 v9, 5, v9
    s_lshl_b32 s3, s45, 8
    s_add_u32 s3, s3, 10240
    buffer_load_dwordx4 v[16:19], v9, s[32:35], s3 offen offset:0
    buffer_load_dwordx4 v[20:23], v9, s[32:35], s3 offen offset:16
    s_waitcnt vmcnt(29)
    v_mfma_f32_32x32x16_bf16 v[192:207], a[16:19], v[72:75], v[192:207]
    v_mfma_f32_32x32x16_bf16 v[224:239], a[20:23], v[72:75], v[224:239]
    s_waitcnt vmcnt(28)
    v_mfma_f32_32x32x16_bf16 v[192:207], a[24:27], v[76:79], v[192:207]
    v_mfma_f32_32x32x16_bf16 v[224:239], a[28:31], v[76:79], v[224:239]
    s_waitcnt vmcnt(27)
    v_mfma_f32_32x32x16_bf16 v[192:207], a[32:35], v[80:83], v[192:207]
    v_mfma_f32_32x32x16_bf16 v[224:239], a[36:39], v[80:83], v[224:239]
    s_waitcnt vmcnt(26)
    v_mfma_f32_32x32x16_bf16 v[192:207], a[40:43], v[84:87], v[192:207]
    v_mfma_f32_32x32x16_bf16 v[224:239], a[44:47], v[84:87], v[224:239]
    s_add_u32 s3, s47, 32768
    buffer_load_dword v51, v53, s[52:55], s3 offen sc1
    s_waitcnt vmcnt(26)
    v_mfma_f32_32x32x16_bf16 v[192:207], a[48:51], v[88:91], v[192:207]
    v_mfma_f32_32x32x16_bf16 v[224:239], a[52:55], v[88:91], v[224:239]
    s_waitcnt vmcnt(25)
    v_mfma_f32_32x32x16_bf16 v[192:207], a[56:59], v[92:95], v[192:207]
    v_mfma_f32_32x32x16_bf16 v[224:239], a[60:63], v[92:95], v[224:239]
    s_waitcnt vmcnt(24)
    v_mfma_f32_32x32x16_bf16 v[192:207], a[64:67], v[96:99], v[192:207]
    v_mfma_f32_32x32x16_bf16 v[224:239], a[68:71], v[96:99], v[224:239]
    s_waitcnt vmcnt(23)
    v_mfma_f32_32x32x16_bf16 v[192:207], a[72:75], v[100:103], v[192:207]
    v_mfma_f32_32x32x16_bf16 v[224:239], a[76:79], v[100:103], v[224:239]
    s_waitcnt vmcnt(22)
    v_mfma_f32_32x32x16_bf16 v[192:207], a[80:83], v[104:107], v[192:207]
    v_mfma_f32_32x32x16_bf16 v[224:239], a[84:87], v[104:107], v[224:239]
    s_waitcnt vmcnt(21)
    v_mfma_f32_32x32x16_bf16 v[192:207], a[88:91], v[108:111], v[192:207]
    v_mfma_f32_32x32x16_bf16 v[224:239], a[92:95], v[108:111], v[224:239]
    s_waitcnt vmcnt(20)
    v_mfma_f32_32x32x16_bf16 v[192:207], a[96:99], v[112:115], v[192:207]
    v_mfma_f32_32x32x16_bf16 v[224:239], a[100:103], v[112:115], v[224:239]
    s_waitcnt vmcnt(19)
    v_mfma_f32_32x32x16_bf16 v[192:207], a[104:107], v[116:119], v[192:207]
    v_mfma_f32_32x32x16_bf16 v[224:239], a[108:111], v[116:119], v[224:239]
    s_waitcnt vmcnt(0)
    v_cmp_ne_u32 vcc, 1, v51
    s_cbranch_vccz k34_poll1_done
    s_add_u32 s3, s47, 32768
    s_mov_b32 s61, 0
k34_poll1:
    buffer_load_dword v51, v53, s[52:55], s3 offen sc1
    s_waitcnt vmcnt(0)
    v_cmp_ne_u32 vcc, 1, v51
    s_cbranch_vccz k34_poll1_done
    s_add_u32 s61, s61, 1
    s_cmp_lt_u32 s61, 100000
    s_cbranch_scc1 k34_poll1
k34_poll1_done:
    v_mfma_f32_32x32x16_bf16 v[192:207], a[112:115], v[120:123], v[192:207]
    s_mov_b32 s36, 229376
    buffer_load_dwordx4 v[64:67], v7, s[40:43], s36 offen offset:0 sc1
    v_mfma_f32_32x32x16_bf16 v[224:239], a[116:119], v[120:123], v[224:239]
    v_mfma_f32_32x32x16_bf16 v[192:207], a[120:123], v[124:127], v[192:207]
    s_mov_b32 s36, 229376
    buffer_load_dwordx4 v[68:71], v7, s[40:43], s36 offen offset:1024 sc1
    v_mfma_f32_32x32x16_bf16 v[224:239], a[124:127], v[124:127], v[224:239]
    v_mfma_f32_32x32x16_bf16 v[192:207], a[128:131], v[128:131], v[192:207]
    s_mov_b32 s36, 229376
    buffer_load_dwordx4 v[72:75], v7, s[40:43], s36 offen offset:2048 sc1
    v_mfma_f32_32x32x16_bf16 v[224:239], a[132:135], v[128:131], v[224:239]
    v_mfma_f32_32x32x16_bf16 v[192:207], a[136:139], v[132:135], v[192:207]
    s_mov_b32 s36, 229376
    buffer_load_dwordx4 v[76:79], v7, s[40:43], s36 offen offset:3072 sc1
    v_mfma_f32_32x32x16_bf16 v[224:239], a[140:143], v[132:135], v[224:239]
    v_mfma_f32_32x32x16_bf16 v[192:207], a[144:147], v[136:139], v[192:207]
    s_mov_b32 s36, 233472
    buffer_load_dwordx4 v[80:83], v7, s[40:43], s36 offen offset:0 sc1
    v_mfma_f32_32x32x16_bf16 v[224:239], a[148:151], v[136:139], v[224:239]
    v_mfma_f32_32x32x16_bf16 v[192:207], a[152:155], v[140:143], v[192:207]
    s_mov_b32 s36, 233472
    buffer_load_dwordx4 v[84:87], v7, s[40:43], s36 offen offset:1024 sc1
    v_mfma_f32_32x32x16_bf16 v[224:239], a[156:159], v[140:143], v[224:239]
    v_mfma_f32_32x32x16_bf16 v[192:207], a[160:163], v[144:147], v[192:207]
    s_mov_b32 s36, 233472
    buffer_load_dwordx4 v[88:91], v7, s[40:43], s36 offen offset:2048 sc1
    v_mfma_f32_32x32x16_bf16 v[224:239], a[164:167], v[144:147], v[224:239]
    v_mfma_f32_32x32x16_bf16 v[192:207], a[168:171], v[148:151], v[192:207]
    s_mov_b32 s36, 233472
    buffer_load_dwordx4 v[92:95], v7, s[40:43], s36 offen offset:3072 sc1
    v_mfma_f32_32x32x16_bf16 v[224:239], a[172:175], v[148:151], v[224:239]
    v_mfma_f32_32x32x16_bf16 v[192:207], a[176:179], v[152:155], v[192:207]
    s_mov_b32 s36, 237568
    buffer_load_dwordx4 v[96:99], v7, s[40:43], s36 offen offset:0 sc1
    v_mfma_f32_32x32x16_bf16 v[224:239], a[180:183], v[152:155], v[224:239]
    v_mfma_f32_32x32x16_bf16 v[192:207], a[184:187], v[156:159], v[192:207]
    s_mov_b32 s36, 237568
    buffer_load_dwordx4 v[100:103], v7, s[40:43], s36 offen offset:1024 sc1
    v_mfma_f32_32x32x16_bf16 v[224:239], a[188:191], v[156:159], v[224:239]
    v_mfma_f32_32x32x16_bf16 v[192:207], a[192:195], v[160:163], v[192:207]
    s_mov_b32 s36, 237568
    buffer_load_dwordx4 v[104:107], v7, s[40:43], s36 offen offset:2048 sc1
    v_mfma_f32_32x32x16_bf16 v[224:239], a[196:199], v[160:163], v[224:239]
    v_mfma_f32_32x32x16_bf16 v[192:207], a[200:203], v[164:167], v[192:207]
    s_mov_b32 s36, 237568
    buffer_load_dwordx4 v[108:111], v7, s[40:43], s36 offen offset:3072 sc1
    v_mfma_f32_32x32x16_bf16 v[224:239], a[204:207], v[164:167], v[224:239]
    v_mfma_f32_32x32x16_bf16 v[192:207], a[208:211], v[168:171], v[192:207]
    s_mov_b32 s36, 241664
    buffer_load_dwordx4 v[112:115], v7, s[40:43], s36 offen offset:0 sc1
    v_mfma_f32_32x32x16_bf16 v[224:239], a[212:215], v[168:171], v[224:239]
    v_mfma_f32_32x32x16_bf16 v[192:207], a[216:219], v[172:175], v[192:207]
    s_mov_b32 s36, 241664
    buffer_load_dwordx4 v[116:119], v7, s[40:43], s36 offen offset:1024 sc1
    v_mfma_f32_32x32x16_bf16 v[224:239], a[220:223], v[172:175], v[224:239]
    s_waitcnt vmcnt(13)
    v_mfma_f32_32x32x16_bf16 v[208:223], a[0:3], v[64:67], 0
    s_mov_b32 s36, 241664
    buffer_load_dwordx4 v[120:123], v7, s[40:43], s36 offen offset:2048 sc1
    v_mfma_f32_32x32x16_bf16 v[240:255], a[4:7], v[64:67], 0
    s_waitcnt vmcnt(13)
    v_mfma_f32_32x32x16_bf16 v[208:223], a[8:11], v[68:71], v[208:223]
    s_mov_b32 s36, 241664
    buffer_load_dwordx4 v[124:127], v7, s[40:43], s36 offen offset:3072 sc1
    v_mfma_f32_32x32x16_bf16 v[240:255], a[12:15], v[68:71], v[240:255]
    s_waitcnt vmcnt(13)
    v_mfma_f32_32x32x16_bf16 v[208:223], a[16:19], v[72:75], v[208:223]
    s_mov_b32 s36, 245760
    buffer_load_dwordx4 v[128:131], v7, s[40:43], s36 offen offset:0 sc1
    v_mfma_f32_32x32x16_bf16 v[240:255], a[20:23], v[72:75], v[240:255]
    v_and_b32 v10, 31, v2
    v_mul_u32_u24 v10, 272, v10
    v_lshrrev_b32 v11, 5, v2
    v_lshl_add_u32 v10, v11, 4, v10
    s_mul_i32 s3, s10, 8704
    s_add_u32 s3, s3, 8192
    v_add_u32 v10, s3, v10
    ds_write_b128 v10, v[192:195] offset:0
    ds_write_b128 v10, v[196:199] offset:32
    ds_write_b128 v10, v[200:203] offset:64
    ds_write_b128 v10, v[204:207] offset:96
    ds_write_b128 v10, v[224:227] offset:128
    ds_write_b128 v10, v[228:231] offset:160
    ds_write_b128 v10, v[232:235] offset:192
    ds_write_b128 v10, v[236:239] offset:224
    s_waitcnt vmcnt(13)
    v_mfma_f32_32x32x16_bf16 v[208:223], a[24:27], v[76:79], v[208:223]
    s_mov_b32 s36, 245760
    buffer_load_dwordx4 v[132:135], v7, s[40:43], s36 offen offset:1024 sc1
    v_mfma_f32_32x32x16_bf16 v[240:255], a[28:31], v[76:79], v[240:255]
    s_waitcnt vmcnt(13)
    v_mfma_f32_32x32x16_bf16 v[208:223], a[32:35], v[80:83], v[208:223]
    s_mov_b32 s36, 245760
    buffer_load_dwordx4 v[136:139], v7, s[40:43], s36 offen offset:2048 sc1
    v_mfma_f32_32x32x16_bf16 v[240:255], a[36:39], v[80:83], v[240:255]
    s_waitcnt vmcnt(13)
    v_mfma_f32_32x32x16_bf16 v[208:223], a[40:43], v[84:87], v[208:223]
    s_mov_b32 s36, 245760
    buffer_load_dwordx4 v[140:143], v7, s[40:43], s36 offen offset:3072 sc1
    v_mfma_f32_32x32x16_bf16 v[240:255], a[44:47], v[84:87], v[240:255]
    s_waitcnt vmcnt(13)
    v_mfma_f32_32x32x16_bf16 v[208:223], a[48:51], v[88:91], v[208:223]
    s_mov_b32 s36, 249856
    buffer_load_dwordx4 v[144:147], v7, s[40:43], s36 offen offset:0 sc1
    v_mfma_f32_32x32x16_bf16 v[240:255], a[52:55], v[88:91], v[240:255]
    s_waitcnt vmcnt(13)
    v_mfma_f32_32x32x16_bf16 v[208:223], a[56:59], v[92:95], v[208:223]
    s_mov_b32 s36, 249856
    buffer_load_dwordx4 v[148:151], v7, s[40:43], s36 offen offset:1024 sc1
    v_mfma_f32_32x32x16_bf16 v[240:255], a[60:63], v[92:95], v[240:255]
    s_waitcnt vmcnt(13)
    v_mfma_f32_32x32x16_bf16 v[208:223], a[64:67], v[96:99], v[208:223]
    s_mov_b32 s36, 249856
    buffer_load_dwordx4 v[152:155], v7, s[40:43], s36 offen offset:2048 sc1
    v_mfma_f32_32x32x16_bf16 v[240:255], a[68:71], v[96:99], v[240:255]
    s_waitcnt lgkmcnt(0)
    s_barrier
    v_lshrrev_b32 v8, 4, v2
    s_lshr_b32 s3, s10, 1
    s_lshl_b32 s3, s3, 2
    v_add_u32 v8, s3, v8
    v_and_b32 v13, 15, v2
    s_and_b32 s3, s10, 1
    s_lshl_b32 s3, s3, 4
    v_add_u32 v13, s3, v13
    v_mul_u32_u24 v14, 272, v13
    v_lshl_add_u32 v14, v8, 5, v14
    v_add_u32 v14, 8192, v14
    v_lshrrev_b32 v12, 2, v2
    v_and_b32 v12, 3, v12
    v_lshl_add_u32 v12, v8, 3, v12
    v_lshlrev_b32 v12, 7, v12
    v_and_b32 v15, 3, v2
    v_lshl_add_u32 v12, v15, 3, v12
    s_lshl_b32 s3, s3, 1
    v_add_u32 v12, s3, v12
    s_lshl_b32 s3, s46, 5
    v_add_u32 v13, s3, v13
    v_lshlrev_b32 v13, 10, v13
    v_lshl_add_u32 v13, v8, 4, v13
    s_lshl_b32 s3, s45, 7
    v_add_u32 v13, s3, v13
    ds_read_b64_tr_b16 v[32:33], v12 offset:0
    ds_read_b64_tr_b16 v[34:35], v12 offset:512
    ds_read_b128 v[36:39], v14 offset:0
    ds_read_b128 v[40:43], v14 offset:16
    ds_read_b128 v[44:47], v14 offset:8704
    ds_read_b128 v[48:51], v14 offset:8720
    ds_read_b128 v[52:55], v14 offset:17408
    ds_read_b128 v[56:59], v14 offset:17424
    ds_read_b128 v[60:63], v14 offset:26112
    ds_read_b128 v[64:67], v14 offset:26128
    s_waitcnt lgkmcnt(0)
    v_add_f32 v36, v36, v44
    v_add_f32 v52, v52, v60
    v_add_f32 v37, v37, v45
    v_add_f32 v53, v53, v61
    v_add_f32 v38, v38, v46
    v_add_f32 v54, v54, v62
    v_add_f32 v39, v39, v47
    v_add_f32 v55, v55, v63
    v_add_f32 v40, v40, v48
    v_add_f32 v56, v56, v64
    v_add_f32 v41, v41, v49
    v_add_f32 v57, v57, v65
    v_add_f32 v42, v42, v50
    v_add_f32 v58, v58, v66
    v_add_f32 v43, v43, v51
    v_add_f32 v59, v59, v67
    v_add_f32 v36, v36, v52
    v_add_f32 v37, v37, v53
    v_add_f32 v38, v38, v54
    v_add_f32 v39, v39, v55
    v_add_f32 v40, v40, v56
    v_add_f32 v41, v41, v57
    v_add_f32 v42, v42, v58
    v_add_f32 v43, v43, v59
    v_lshlrev_b32 v44, 16, v32
    v_fma_f32 v36, v36, v16, v44
    v_and_b32 v44, 0xffff0000, v32
    v_fma_f32 v37, v37, v17, v44
    v_lshlrev_b32 v44, 16, v33
    v_fma_f32 v38, v38, v18, v44
    v_and_b32 v44, 0xffff0000, v33
    v_fma_f32 v39, v39, v19, v44
    v_lshlrev_b32 v44, 16, v34
    v_fma_f32 v40, v40, v20, v44
    v_and_b32 v44, 0xffff0000, v34
    v_fma_f32 v41, v41, v21, v44
    v_lshlrev_b32 v44, 16, v35
    v_fma_f32 v42, v42, v22, v44
    v_and_b32 v44, 0xffff0000, v35
    v_fma_f32 v43, v43, v23, v44
    v_cvt_pk_bf16_f32 v52, v36, v37
    v_cvt_pk_bf16_f32 v53, v38, v39
    v_cvt_pk_bf16_f32 v54, v40, v41
    v_cvt_pk_bf16_f32 v55, v42, v43
    s_mov_b32 s3, 0
    buffer_store_dwordx4 v[52:55], v13, s[28:31], s3 offen sc1
    s_waitcnt vmcnt(14)
    v_mfma_f32_32x32x16_bf16 v[208:223], a[72:75], v[100:103], v[208:223]
    s_mov_b32 s36, 249856
    buffer_load_dwordx4 v[156:159], v7, s[40:43], s36 offen offset:3072 sc1
    v_mfma_f32_32x32x16_bf16 v[240:255], a[76:79], v[100:103], v[240:255]
    s_waitcnt vmcnt(14)
    v_mfma_f32_32x32x16_bf16 v[208:223], a[80:83], v[104:107], v[208:223]
    s_mov_b32 s36, 253952
    buffer_load_dwordx4 v[160:163], v7, s[40:43], s36 offen offset:0 sc1
    v_mfma_f32_32x32x16_bf16 v[240:255], a[84:87], v[104:107], v[240:255]
    s_waitcnt vmcnt(14)
    v_mfma_f32_32x32x16_bf16 v[208:223], a[88:91], v[108:111], v[208:223]
    s_mov_b32 s36, 253952
    buffer_load_dwordx4 v[164:167], v7, s[40:43], s36 offen offset:1024 sc1
    v_mfma_f32_32x32x16_bf16 v[240:255], a[92:95], v[108:111], v[240:255]
    s_waitcnt vmcnt(14)
    v_mfma_f32_32x32x16_bf16 v[208:223], a[96:99], v[112:115], v[208:223]
    s_mov_b32 s36, 253952
    buffer_load_dwordx4 v[168:171], v7, s[40:43], s36 offen offset:2048 sc1
    v_mfma_f32_32x32x16_bf16 v[240:255], a[100:103], v[112:115], v[240:255]
    s_waitcnt vmcnt(14)
    v_mfma_f32_32x32x16_bf16 v[208:223], a[104:107], v[116:119], v[208:223]
    s_mov_b32 s36, 253952
    buffer_load_dwordx4 v[172:175], v7, s[40:43], s36 offen offset:3072 sc1
    v_mfma_f32_32x32x16_bf16 v[240:255], a[108:111], v[116:119], v[240:255]
    s_waitcnt vmcnt(14)
    v_mfma_f32_32x32x16_bf16 v[208:223], a[112:115], v[120:123], v[208:223]
    v_mfma_f32_32x32x16_bf16 v[240:255], a[116:119], v[120:123], v[240:255]
    s_waitcnt vmcnt(13)
    v_mfma_f32_32x32x16_bf16 v[208:223], a[120:123], v[124:127], v[208:223]
    v_mfma_f32_32x32x16_bf16 v[240:255], a[124:127], v[124:127], v[240:255]
    s_waitcnt vmcnt(12)
    v_mfma_f32_32x32x16_bf16 v[208:223], a[128:131], v[128:131], v[208:223]
    v_mfma_f32_32x32x16_bf16 v[240:255], a[132:135], v[128:131], v[240:255]
    s_waitcnt vmcnt(11)
    v_mfma_f32_32x32x16_bf16 v[208:223], a[136:139], v[132:135], v[208:223]
    v_mfma_f32_32x32x16_bf16 v[240:255], a[140:143], v[132:135], v[240:255]
    s_waitcnt vmcnt(10)
    v_mfma_f32_32x32x16_bf16 v[208:223], a[144:147], v[136:139], v[208:223]
    v_mfma_f32_32x32x16_bf16 v[240:255], a[148:151], v[136:139], v[240:255]
    s_waitcnt vmcnt(9)
    v_mfma_f32_32x32x16_bf16 v[208:223], a[152:155], v[140:143], v[208:223]
    v_mfma_f32_32x32x16_bf16 v[240:255], a[156:159], v[140:143], v[240:255]
    s_waitcnt vmcnt(8)
    v_mfma_f32_32x32x16_bf16 v[208:223], a[160:163], v[144:147], v[208:223]
    v_mfma_f32_32x32x16_bf16 v[240:255], a[164:167], v[144:147], v[240:255]
    s_waitcnt vmcnt(7)
    v_mfma_f32_32x32x16_bf16 v[208:223], a[168:171], v[148:151], v[208:223]
    v_mfma_f32_32x32x16_bf16 v[240:255], a[172:175], v[148:151], v[240:255]
    s_waitcnt vmcnt(6)
    v_mfma_f32_32x32x16_bf16 v[208:223], a[176:179], v[152:155], v[208:223]
    v_mfma_f32_32x32x16_bf16 v[240:255], a[180:183], v[152:155], v[240:255]
    s_waitcnt vmcnt(4)
    v_mfma_f32_32x32x16_bf16 v[208:223], a[184:187], v[156:159], v[208:223]
    v_mfma_f32_32x32x16_bf16 v[240:255], a[188:191], v[156:159], v[240:255]
    s_waitcnt vmcnt(3)
    v_mfma_f32_32x32x16_bf16 v[208:223], a[192:195], v[160:163], v[208:223]
    v_mfma_f32_32x32x16_bf16 v[240:255], a[196:199], v[160:163], v[240:255]
    s_waitcnt vmcnt(2)
    v_mfma_f32_32x32x16_bf16 v[208:223], a[200:203], v[164:167], v[208:223]
    v_mfma_f32_32x32x16_bf16 v[240:255], a[204:207], v[164:167], v[240:255]
    s_waitcnt vmcnt(1)
    v_mfma_f32_32x32x16_bf16 v[208:223], a[208:211], v[168:171], v[208:223]
    v_mfma_f32_32x32x16_bf16 v[240:255], a[212:215], v[168:171], v[240:255]
    s_waitcnt vmcnt(0)
    v_mfma_f32_32x32x16_bf16 v[208:223], a[216:219], v[172:175], v[208:223]
    v_mfma_f32_32x32x16_bf16 v[240:255], a[220:223], v[172:175], v[240:255]
    s_nop 10
    ds_write_b128 v10, v[208:211] offset:34816
    ds_write_b128 v10, v[212:215] offset:34848
    ds_write_b128 v10, v[216:219] offset:34880
    ds_write_b128 v10, v[220:223] offset:34912
    ds_write_b128 v10, v[240:243] offset:34944
    ds_write_b128 v10, v[244:247] offset:34976
    ds_write_b128 v10, v[248:251] offset:35008
    ds_write_b128 v10, v[252:255] offset:35040
    s_waitcnt lgkmcnt(0)
    s_barrier
    ds_read_b64_tr_b16 v[32:33], v12 offset:64
    ds_read_b64_tr_b16 v[34:35], v12 offset:576
    ds_read_b128 v[36:39], v14 offset:34816
    ds_read_b128 v[40:43], v14 offset:34832
    ds_read_b128 v[44:47], v14 offset:43520
    ds_read_b128 v[48:51], v14 offset:43536
    ds_read_b128 v[52:55], v14 offset:52224
    ds_read_b128 v[56:59], v14 offset:52240
    ds_read_b128 v[60:63], v14 offset:60928
    ds_read_b128 v[64:67], v14 offset:60944
    s_waitcnt lgkmcnt(0)
    v_add_f32 v36, v36, v44
    v_add_f32 v52, v52, v60
    v_add_f32 v37, v37, v45
    v_add_f32 v53, v53, v61
    v_add_f32 v38, v38, v46
    v_add_f32 v54, v54, v62
    v_add_f32 v39, v39, v47
    v_add_f32 v55, v55, v63
    v_add_f32 v40, v40, v48
    v_add_f32 v56, v56, v64
    v_add_f32 v41, v41, v49
    v_add_f32 v57, v57, v65
    v_add_f32 v42, v42, v50
    v_add_f32 v58, v58, v66
    v_add_f32 v43, v43, v51
    v_add_f32 v59, v59, v67
    v_add_f32 v36, v36, v52
    v_add_f32 v37, v37, v53
    v_add_f32 v38, v38, v54
    v_add_f32 v39, v39, v55
    v_add_f32 v40, v40, v56
    v_add_f32 v41, v41, v57
    v_add_f32 v42, v42, v58
    v_add_f32 v43, v43, v59
    v_lshlrev_b32 v44, 16, v32
    v_fma_f32 v36, v36, v16, v44
    v_and_b32 v44, 0xffff0000, v32
    v_fma_f32 v37, v37, v17, v44
    v_lshlrev_b32 v44, 16, v33
    v_fma_f32 v38, v38, v18, v44
    v_and_b32 v44, 0xffff0000, v33
    v_fma_f32 v39, v39, v19, v44
    v_lshlrev_b32 v44, 16, v34
    v_fma_f32 v40, v40, v20, v44
    v_and_b32 v44, 0xffff0000, v34
    v_fma_f32 v41, v41, v21, v44
    v_lshlrev_b32 v44, 16, v35
    v_fma_f32 v42, v42, v22, v44
    v_and_b32 v44, 0xffff0000, v35
    v_fma_f32 v43, v43, v23, v44
    v_cvt_pk_bf16_f32 v52, v36, v37
    v_cvt_pk_bf16_f32 v53, v38, v39
    v_cvt_pk_bf16_f32 v54, v40, v41
    v_cvt_pk_bf16_f32 v55, v42, v43
    s_mov_b32 s3, 65536
    buffer_store_dwordx4 v[52:55], v13, s[28:31], s3 offen sc1
    s_endpgm
k34_done:
    s_endpgm
.section .rodata,"a"
.p2align 6
.amdhsa_kernel k1_prep_kernel
  .amdhsa_next_free_vgpr 208
  .amdhsa_next_free_sgpr 80
  .amdhsa_accum_offset 208
  .amdhsa_group_segment_fixed_size 0
  .amdhsa_kernarg_size 112
  .amdhsa_user_sgpr_count 2
  .amdhsa_user_sgpr_kernarg_segment_ptr 1
  .amdhsa_system_sgpr_workgroup_id_x 1
  .amdhsa_float_denorm_mode_32 3
.end_amdhsa_kernel
.p2align 6
.amdhsa_kernel k2_conv_kernel
  .amdhsa_next_free_vgpr 256
  .amdhsa_next_free_sgpr 80
  .amdhsa_accum_offset 256
  .amdhsa_group_segment_fixed_size 0
  .amdhsa_kernarg_size 112
  .amdhsa_user_sgpr_count 2
  .amdhsa_user_sgpr_kernarg_segment_ptr 1
  .amdhsa_system_sgpr_workgroup_id_x 1
  .amdhsa_float_denorm_mode_32 3
.end_amdhsa_kernel
.p2align 6
.amdhsa_kernel k34_ffn_kernel
  .amdhsa_next_free_vgpr 512
  .amdhsa_next_free_sgpr 80
  .amdhsa_accum_offset 256
  .amdhsa_group_segment_fixed_size 0
  .amdhsa_kernarg_size 112
  .amdhsa_user_sgpr_count 2
  .amdhsa_user_sgpr_kernarg_segment_ptr 1
  .amdhsa_system_sgpr_workgroup_id_x 1
  .amdhsa_float_denorm_mode_32 3
.end_amdhsa_kernel
```
